```python
import torch

def _softmax(x, axis=-1):
    return torch.softmax(x, dim=axis)
def _gelu(x):
    return torch.nn.functional.gelu(x, approximate="tanh")
def _silu(x):
    return torch.nn.functional.silu(x)
def _sigmoid(x):
    return torch.sigmoid(x)
def _layernorm(x, axis=-1, eps=1e-5):
    m = x.mean(dim=axis, keepdim=True)
    v = x.var(dim=axis, keepdim=True, unbiased=False)
    return (x - m) / torch.sqrt(v + eps)
def _scatter_add(tgt, idx, src, axis=0):
    return tgt.clone().index_add_(axis, idx, src)
def _segment_sum(src, seg, n):
    out = torch.zeros((n,) + src.shape[1:], dtype=src.dtype)
    return out.index_add_(0, seg, src)
def _pad(x, pw):
    flat = tuple(v for pair in reversed(pw) for v in pair)
    return torch.nn.functional.pad(x, flat)

kernel_name = 'concat_heads__mha_block_cached__gqa_block_cached__near_ridge'

def setup_inputs():

    _w = (lambda a: (lambda t: t.to(torch.bfloat16) if t.is_floating_point() else t)(torch.as_tensor(a)))
    def _A_setup():
        B, Sq, D = 8, 224, 512
        H, Sk, Dh = 32, 1024, 128
        return {
            "x": _w((lambda *s: torch.randn(*s, dtype=torch.bfloat16) * 0.8)(B, Sq, D)),
            "k_cache": _w((lambda *s: torch.randn(*s, dtype=torch.bfloat16) * 0.8)(B, H, Sk, Dh)),
            "v_cache": _w((lambda *s: torch.randn(*s, dtype=torch.bfloat16) * 0.05)(B, H, Sk, Dh)),
            "wq": _w((lambda *s: torch.randn(*s, dtype=torch.bfloat16) * 0.8)(D, H * Dh) * (D ** -0.5)),
            "wo": _w((lambda *s: torch.randn(*s, dtype=torch.bfloat16) * 0.05)(H * Dh, D) * ((H * Dh) ** -0.5)),
        }
    _A_in = _A_setup()

    def _B_setup():
        B, Sq, D = 8, 224, 512
        Hq, Hkv, Sk, Dh = 32, 32, 1024, 128
        assert Hq % Hkv == 0, (Hq, Hkv)
        return {
            "x": _w((lambda *s: torch.randn(*s, dtype=torch.bfloat16) * 0.8)(B, Sq, D)),
            "k_cache": _w((lambda *s: torch.randn(*s, dtype=torch.bfloat16) * 0.8)(B, Hkv, Sk, Dh)),
            "v_cache": _w((lambda *s: torch.randn(*s, dtype=torch.bfloat16) * 0.05)(B, Hkv, Sk, Dh)),
            "wq": _w((lambda *s: torch.randn(*s, dtype=torch.bfloat16) * 0.8)(D, Hq * Dh) * (D ** -0.5)),
            "wo": _w((lambda *s: torch.randn(*s, dtype=torch.bfloat16) * 0.05)(Hq * Dh, D) * ((Hq * Dh) ** -0.5)),
        }
    _B_in = _B_setup()

    return {
        "A_x": _A_in["x"],
        "A_k_cache": _A_in["k_cache"],
        "A_v_cache": _A_in["v_cache"],
        "A_wq": _A_in["wq"],
        "A_wo": _A_in["wo"],
        "B_x": _B_in["x"],
        "B_k_cache": _B_in["k_cache"],
        "B_v_cache": _B_in["v_cache"],
        "B_wq": _B_in["wq"],
        "B_wo": _B_in["wo"],
    }

def reference(A_x, A_k_cache, A_v_cache, A_wq, A_wo, B_x, B_k_cache, B_v_cache, B_wq, B_wo):
    def _A_ref(x, k_cache, v_cache, wq, wo):
        B, Sq, D = x.shape
        H, Dh = 32, 128
        q = (lambda x, *d: x.permute(*d))((x @ wq).reshape(B, Sq, H, Dh), 0, 2, 1, 3)
        scores = torch.einsum("bhqd,bhkd->bhqk", q, k_cache) * (Dh ** -0.5)
        p = _softmax(scores, axis=-1)
        o = torch.einsum("bhqk,bhkd->bhqd", p, v_cache)
        return (lambda x, *d: x.permute(*d))(o, 0, 2, 1, 3).reshape(B, Sq, H * Dh) @ wo

    def _B_ref(x, k_cache, v_cache, wq, wo):
        B, Sq, D = x.shape
        Hq, Dh = 32, 128
        Hkv = k_cache.shape[1]
        rep = Hq // Hkv
        q = (lambda x, *d: x.permute(*d))((x @ wq).reshape(B, Sq, Hq, Dh), 0, 2, 1, 3)
        k = (lambda x, n, axis: torch.repeat_interleave(x, n, dim=axis))(k_cache, rep, axis=1)
        v = (lambda x, n, axis: torch.repeat_interleave(x, n, dim=axis))(v_cache, rep, axis=1)
        scores = torch.einsum("bhqd,bhkd->bhqk", q, k) * (Dh ** -0.5)
        p = _softmax(scores, axis=-1)
        o = torch.einsum("bhqk,bhkd->bhqd", p, v)
        return (lambda x, *d: x.permute(*d))(o, 0, 2, 1, 3).reshape(B, Sq, Hq * Dh) @ wo

    a = _A_ref(A_x, A_k_cache, A_v_cache, A_wq, A_wo)
    b = _B_ref(B_x, B_k_cache, B_v_cache, B_wq, B_wo)
    return torch.concatenate([a, b], axis=-1)
```

```asm
; @launch kernel=attn_kernel grid=(256,1,1) block=(512,1,1) lds=159744
; @launch kernel=oproj_kernel grid=(224,1,1) block=(256,1,1) lds=131072
.amdgcn_target "amdgcn-amd-amdhsa--gfx950"
.text
.globl attn_kernel
.p2align 8
.type attn_kernel,@function
attn_kernel:
  s_cmp_ge_u32 s2, 256
  s_cbranch_scc1 K1_EXIT
  s_load_dwordx8 s[44:51], s[0:1], 0
  s_load_dwordx8 s[52:59], s[0:1], 40
  s_load_dwordx2 s[60:61], s[0:1], 96
  v_lshrrev_b32 v1, 6, v0
  v_and_b32 v0, 63, v0
  s_and_b32 s28, s2, 7
  v_readfirstlane_b32 s3, v1
  s_lshr_b32 s29, s2, 3
  s_and_b32 s4, s29, 3
  s_lshl_b32 s28, s28, 2
  s_add_u32 s4, s4, s28
  s_lshr_b32 s5, s29, 2
  s_mov_b32 s10, 0x40000
  s_mov_b32 s11, 0x20000
  s_mov_b32 s14, 0x40000
  s_mov_b32 s15, 0x20000
  s_mov_b32 s19, 0x20000
  s_mov_b32 s22, 229376
  s_mov_b32 s23, 0x20000
  s_mov_b32 s26, 8192
  s_mov_b32 s27, 0x20000
  s_mov_b32 s63, 0x3e0293ee
  s_mov_b32 s64, 4096
  s_mov_b32 s7, 0
  s_mov_b32 s37, 0
  s_mov_b32 s38, 0
  s_mov_b32 s40, 0
  s_mov_b32 s41, 0
  s_mov_b32 s62, 2
  s_mov_b32 s65, 0
  s_waitcnt lgkmcnt(0)
  v_and_b32 v244, 31, v0
  v_lshrrev_b32 v245, 5, v0
  v_and_b32 v246, 15, v0
  v_lshlrev_b32 v247, 8, v244
  v_add_u32 v248, 0, v245
  v_xor_b32 v248, v248, v246
  v_lshl_add_u32 v2, v248, 4, v247
  v_add_u32 v248, 2, v245
  v_xor_b32 v248, v248, v246
  v_lshl_add_u32 v3, v248, 4, v247
  v_add_u32 v248, 4, v245
  v_xor_b32 v248, v248, v246
  v_lshl_add_u32 v4, v248, 4, v247
  v_add_u32 v248, 6, v245
  v_xor_b32 v248, v248, v246
  v_lshl_add_u32 v5, v248, 4, v247
  v_add_u32 v248, 8, v245
  v_xor_b32 v248, v248, v246
  v_lshl_add_u32 v6, v248, 4, v247
  v_add_u32 v248, 10, v245
  v_xor_b32 v248, v248, v246
  v_lshl_add_u32 v7, v248, 4, v247
  v_add_u32 v248, 12, v245
  v_xor_b32 v248, v248, v246
  v_lshl_add_u32 v8, v248, 4, v247
  v_add_u32 v248, 14, v245
  v_xor_b32 v248, v248, v246
  v_lshl_add_u32 v9, v248, 4, v247
  v_bfe_u32 v248, v0, 2, 2
  v_lshl_add_u32 v249, v245, 2, v248
  v_lshlrev_b32 v249, 8, v249
  v_bfe_u32 v250, v0, 4, 1
  v_lshl_add_u32 v249, v250, 5, v249
  v_and_b32 v250, 1, v0
  v_lshl_add_u32 v249, v250, 4, v249
  v_bfe_u32 v250, v0, 1, 1
  v_lshl_add_u32 v249, v250, 3, v249
  v_xor_b32 v250, 0, v248
  v_lshl_add_u32 v10, v250, 6, v249
  v_xor_b32 v250, 1, v248
  v_lshl_add_u32 v11, v250, 6, v249
  v_xor_b32 v250, 2, v248
  v_lshl_add_u32 v12, v250, 6, v249
  v_xor_b32 v250, 3, v248
  v_lshl_add_u32 v13, v250, 6, v249
  s_lshl_b32 s66, s3, 12
  s_add_u32 s66, s66, 131072
  v_and_b32 v16, 31, v0
  v_lshrrev_b32 v17, 5, v0
  v_bfe_u32 v18, v0, 1, 3
  v_lshlrev_b32 v19, 7, v16
  v_add_u32 v19, s66, v19
  v_add_u32 v20, 0, v17
  v_xor_b32 v20, v20, v18
  v_lshl_add_u32 v245, v20, 4, v19
  v_add_u32 v20, 2, v17
  v_xor_b32 v20, v20, v18
  v_lshl_add_u32 v246, v20, 4, v19
  v_add_u32 v20, 4, v17
  v_xor_b32 v20, v20, v18
  v_lshl_add_u32 v247, v20, 4, v19
  v_add_u32 v20, 6, v17
  v_xor_b32 v20, v20, v18
  v_lshl_add_u32 v248, v20, 4, v19
  v_lshrrev_b32 v16, 3, v0
  s_lshl_b32 s28, s3, 5
  v_add_u32 v17, s28, v16
  v_lshlrev_b32 v17, 10, v17
  v_lshrrev_b32 v18, 1, v16
  v_and_b32 v19, 7, v0
  v_xor_b32 v20, v19, v18
  v_lshl_add_u32 v240, v20, 4, v17
  v_xor_b32 v20, 4, v20
  v_lshl_add_u32 v244, v20, 4, v17
  v_lshlrev_b32 v241, 4, v0
  v_lshrrev_b32 v16, 4, v0
  v_and_b32 v17, 15, v0
  v_add_u32 v18, 0, v16
  v_xor_b32 v18, v18, v17
  v_lshlrev_b32 v18, 4, v18
  v_lshl_add_u32 v250, v16, 8, v18
  v_add_u32 v18, 4, v16
  v_xor_b32 v18, v18, v17
  v_lshlrev_b32 v18, 4, v18
  v_lshl_add_u32 v251, v16, 8, v18
  v_add_u32 v18, 8, v16
  v_xor_b32 v18, v18, v17
  v_lshlrev_b32 v18, 4, v18
  v_lshl_add_u32 v252, v16, 8, v18
  v_add_u32 v18, 12, v16
  v_xor_b32 v18, v18, v17
  v_lshlrev_b32 v18, 4, v18
  v_lshl_add_u32 v253, v16, 8, v18
  v_lshlrev_b32 v18, 2, v16
  v_xor_b32 v18, v18, v17
  v_lshlrev_b32 v18, 4, v18
  v_lshl_add_u32 v254, v16, 8, v18
  v_lshl_add_u32 v255, v16, 13, v18
  s_cmp_eq_u32 s3, 7
  s_cbranch_scc0 ITEM
  s_setprio 3
LD_STREAM:
  s_cmp_eq_u32 s7, 0
  s_cselect_b32 s8, s46, s54
  s_cselect_b32 s9, s47, s55
  s_cselect_b32 s12, s48, s56
  s_cselect_b32 s13, s49, s57
  s_cselect_b32 s16, s50, s58
  s_cselect_b32 s17, s51, s59
  s_lshl_b32 s28, s5, 5
  s_add_u32 s28, s28, s4
  s_lshl_b32 s28, s28, 18
  s_add_u32 s8, s8, s28
  s_addc_u32 s9, s9, 0
  s_add_u32 s12, s12, s28
  s_addc_u32 s13, s13, 0
  s_lshl_b32 s28, s4, 8
  s_add_u32 s16, s16, s28
  s_addc_u32 s17, s17, 0
  s_sub_u32 s18, 0x400000, s28
  s_mul_i32 s28, s7, 56
  s_mul_i32 s29, s5, 7
  s_add_u32 s28, s28, s29
  s_add_u32 s28, s28, s3
  s_lshl_b32 s28, s28, 18
  s_lshl_b32 s29, s4, 13
  s_add_u32 s28, s28, s29
  s_add_u32 s24, s60, s28
  s_addc_u32 s25, s61, 0
  s_mov_b32 s30, 0
  s_mov_b32 s36, 3
LD_PRO:
  s_add_u32 m0, s37, 0
  s_add_u32 s31, s30, 0
  buffer_load_dwordx4 v255, s[16:19], s31 offen lds
  s_add_u32 m0, s37, 1024
  s_add_u32 s31, s30, 65536
  buffer_load_dwordx4 v255, s[16:19], s31 offen lds
  s_add_u32 m0, s37, 2048
  s_add_u32 s31, s30, 32768
  buffer_load_dwordx4 v255, s[16:19], s31 offen lds
  s_add_u32 m0, s37, 3072
  s_add_u32 s31, s30, 98304
  buffer_load_dwordx4 v255, s[16:19], s31 offen lds
  s_add_u32 m0, s37, 4096
  s_add_u32 s31, s30, 131072
  buffer_load_dwordx4 v255, s[16:19], s31 offen lds
  s_add_u32 m0, s37, 5120
  s_add_u32 s31, s30, 196608
  buffer_load_dwordx4 v255, s[16:19], s31 offen lds
  s_add_u32 m0, s37, 6144
  s_add_u32 s31, s30, 163840
  buffer_load_dwordx4 v255, s[16:19], s31 offen lds
  s_add_u32 m0, s37, 7168
  s_add_u32 s31, s30, 229376
  buffer_load_dwordx4 v255, s[16:19], s31 offen lds
  s_add_u32 m0, s37, 8192
  s_add_u32 s31, s30, 262144
  buffer_load_dwordx4 v255, s[16:19], s31 offen lds
  s_add_u32 m0, s37, 9216
  s_add_u32 s31, s30, 327680
  buffer_load_dwordx4 v255, s[16:19], s31 offen lds
  s_add_u32 m0, s37, 10240
  s_add_u32 s31, s30, 294912
  buffer_load_dwordx4 v255, s[16:19], s31 offen lds
  s_add_u32 m0, s37, 11264
  s_add_u32 s31, s30, 360448
  buffer_load_dwordx4 v255, s[16:19], s31 offen lds
  s_add_u32 m0, s37, 12288
  s_add_u32 s31, s30, 393216
  buffer_load_dwordx4 v255, s[16:19], s31 offen lds
  s_add_u32 m0, s37, 13312
  s_add_u32 s31, s30, 458752
  buffer_load_dwordx4 v255, s[16:19], s31 offen lds
  s_add_u32 m0, s37, 14336
  s_add_u32 s31, s30, 425984
  buffer_load_dwordx4 v255, s[16:19], s31 offen lds
  s_add_u32 m0, s37, 15360
  s_add_u32 s31, s30, 491520
  buffer_load_dwordx4 v255, s[16:19], s31 offen lds
  s_add_u32 m0, s37, 16384
  s_add_u32 s31, s30, 524288
  buffer_load_dwordx4 v255, s[16:19], s31 offen lds
  s_add_u32 m0, s37, 17408
  s_add_u32 s31, s30, 589824
  buffer_load_dwordx4 v255, s[16:19], s31 offen lds
  s_add_u32 m0, s37, 18432
  s_add_u32 s31, s30, 557056
  buffer_load_dwordx4 v255, s[16:19], s31 offen lds
  s_add_u32 m0, s37, 19456
  s_add_u32 s31, s30, 622592
  buffer_load_dwordx4 v255, s[16:19], s31 offen lds
  s_add_u32 m0, s37, 20480
  s_add_u32 s31, s30, 655360
  buffer_load_dwordx4 v255, s[16:19], s31 offen lds
  s_add_u32 m0, s37, 21504
  s_add_u32 s31, s30, 720896
  buffer_load_dwordx4 v255, s[16:19], s31 offen lds
  s_add_u32 m0, s37, 22528
  s_add_u32 s31, s30, 688128
  buffer_load_dwordx4 v255, s[16:19], s31 offen lds
  s_add_u32 m0, s37, 23552
  s_add_u32 s31, s30, 753664
  buffer_load_dwordx4 v255, s[16:19], s31 offen lds
  s_add_u32 m0, s37, 24576
  s_add_u32 s31, s30, 786432
  buffer_load_dwordx4 v255, s[16:19], s31 offen lds
  s_add_u32 m0, s37, 25600
  s_add_u32 s31, s30, 851968
  buffer_load_dwordx4 v255, s[16:19], s31 offen lds
  s_add_u32 m0, s37, 26624
  s_add_u32 s31, s30, 819200
  buffer_load_dwordx4 v255, s[16:19], s31 offen lds
  s_add_u32 m0, s37, 27648
  s_add_u32 s31, s30, 884736
  buffer_load_dwordx4 v255, s[16:19], s31 offen lds
  s_add_u32 m0, s37, 28672
  s_add_u32 s31, s30, 917504
  buffer_load_dwordx4 v255, s[16:19], s31 offen lds
  s_add_u32 m0, s37, 29696
  s_add_u32 s31, s30, 983040
  buffer_load_dwordx4 v255, s[16:19], s31 offen lds
  s_add_u32 m0, s37, 30720
  s_add_u32 s31, s30, 950272
  buffer_load_dwordx4 v255, s[16:19], s31 offen lds
  s_add_u32 m0, s37, 31744
  s_add_u32 s31, s30, 1015808
  buffer_load_dwordx4 v255, s[16:19], s31 offen lds
  s_add_u32 s30, s30, 1048576
  s_add_u32 s37, s37, 32768
  s_cmp_eq_u32 s37, 131072
  s_cselect_b32 s37, 0, s37
  s_sub_u32 s36, s36, 1
  s_cmp_lg_u32 s36, 0
  s_cbranch_scc1 LD_PRO
  s_mov_b32 s36, 1
LD_WSTEP:
  s_waitcnt vmcnt(63)
  s_barrier
  s_add_u32 m0, s37, 0
  s_add_u32 s31, s30, 0
  buffer_load_dwordx4 v255, s[16:19], s31 offen lds
  s_add_u32 m0, s37, 1024
  s_add_u32 s31, s30, 65536
  buffer_load_dwordx4 v255, s[16:19], s31 offen lds
  s_add_u32 m0, s37, 2048
  s_add_u32 s31, s30, 32768
  buffer_load_dwordx4 v255, s[16:19], s31 offen lds
  s_add_u32 m0, s37, 3072
  s_add_u32 s31, s30, 98304
  buffer_load_dwordx4 v255, s[16:19], s31 offen lds
  s_add_u32 m0, s37, 4096
  s_add_u32 s31, s30, 131072
  buffer_load_dwordx4 v255, s[16:19], s31 offen lds
  s_add_u32 m0, s37, 5120
  s_add_u32 s31, s30, 196608
  buffer_load_dwordx4 v255, s[16:19], s31 offen lds
  s_add_u32 m0, s37, 6144
  s_add_u32 s31, s30, 163840
  buffer_load_dwordx4 v255, s[16:19], s31 offen lds
  s_add_u32 m0, s37, 7168
  s_add_u32 s31, s30, 229376
  buffer_load_dwordx4 v255, s[16:19], s31 offen lds
  s_add_u32 m0, s37, 8192
  s_add_u32 s31, s30, 262144
  buffer_load_dwordx4 v255, s[16:19], s31 offen lds
  s_add_u32 m0, s37, 9216
  s_add_u32 s31, s30, 327680
  buffer_load_dwordx4 v255, s[16:19], s31 offen lds
  s_add_u32 m0, s37, 10240
  s_add_u32 s31, s30, 294912
  buffer_load_dwordx4 v255, s[16:19], s31 offen lds
  s_add_u32 m0, s37, 11264
  s_add_u32 s31, s30, 360448
  buffer_load_dwordx4 v255, s[16:19], s31 offen lds
  s_add_u32 m0, s37, 12288
  s_add_u32 s31, s30, 393216
  buffer_load_dwordx4 v255, s[16:19], s31 offen lds
  s_add_u32 m0, s37, 13312
  s_add_u32 s31, s30, 458752
  buffer_load_dwordx4 v255, s[16:19], s31 offen lds
  s_add_u32 m0, s37, 14336
  s_add_u32 s31, s30, 425984
  buffer_load_dwordx4 v255, s[16:19], s31 offen lds
  s_add_u32 m0, s37, 15360
  s_add_u32 s31, s30, 491520
  buffer_load_dwordx4 v255, s[16:19], s31 offen lds
  s_add_u32 m0, s37, 16384
  s_add_u32 s31, s30, 524288
  buffer_load_dwordx4 v255, s[16:19], s31 offen lds
  s_add_u32 m0, s37, 17408
  s_add_u32 s31, s30, 589824
  buffer_load_dwordx4 v255, s[16:19], s31 offen lds
  s_add_u32 m0, s37, 18432
  s_add_u32 s31, s30, 557056
  buffer_load_dwordx4 v255, s[16:19], s31 offen lds
  s_add_u32 m0, s37, 19456
  s_add_u32 s31, s30, 622592
  buffer_load_dwordx4 v255, s[16:19], s31 offen lds
  s_add_u32 m0, s37, 20480
  s_add_u32 s31, s30, 655360
  buffer_load_dwordx4 v255, s[16:19], s31 offen lds
  s_add_u32 m0, s37, 21504
  s_add_u32 s31, s30, 720896
  buffer_load_dwordx4 v255, s[16:19], s31 offen lds
  s_add_u32 m0, s37, 22528
  s_add_u32 s31, s30, 688128
  buffer_load_dwordx4 v255, s[16:19], s31 offen lds
  s_add_u32 m0, s37, 23552
  s_add_u32 s31, s30, 753664
  buffer_load_dwordx4 v255, s[16:19], s31 offen lds
  s_add_u32 m0, s37, 24576
  s_add_u32 s31, s30, 786432
  buffer_load_dwordx4 v255, s[16:19], s31 offen lds
  s_add_u32 m0, s37, 25600
  s_add_u32 s31, s30, 851968
  buffer_load_dwordx4 v255, s[16:19], s31 offen lds
  s_add_u32 m0, s37, 26624
  s_add_u32 s31, s30, 819200
  buffer_load_dwordx4 v255, s[16:19], s31 offen lds
  s_add_u32 m0, s37, 27648
  s_add_u32 s31, s30, 884736
  buffer_load_dwordx4 v255, s[16:19], s31 offen lds
  s_add_u32 m0, s37, 28672
  s_add_u32 s31, s30, 917504
  buffer_load_dwordx4 v255, s[16:19], s31 offen lds
  s_add_u32 m0, s37, 29696
  s_add_u32 s31, s30, 983040
  buffer_load_dwordx4 v255, s[16:19], s31 offen lds
  s_add_u32 m0, s37, 30720
  s_add_u32 s31, s30, 950272
  buffer_load_dwordx4 v255, s[16:19], s31 offen lds
  s_add_u32 m0, s37, 31744
  s_add_u32 s31, s30, 1015808
  buffer_load_dwordx4 v255, s[16:19], s31 offen lds
  s_add_u32 s30, s30, 1048576
  s_add_u32 s37, s37, 32768
  s_cmp_eq_u32 s37, 131072
  s_cselect_b32 s37, 0, s37
  s_sub_u32 s36, s36, 1
  s_cmp_lg_u32 s36, 0
  s_cbranch_scc1 LD_WSTEP
  s_mov_b32 s30, 0
  s_mov_b32 s36, 16
LD_KV:
  s_waitcnt vmcnt(63)
  s_barrier
  s_add_u32 m0, s37, 0
  s_add_u32 s31, s30, 0
  buffer_load_dwordx4 v250, s[8:11], s31 offen offset:0 nt lds
  buffer_load_dwordx4 v251, s[8:11], s31 offen offset:1024 nt lds
  buffer_load_dwordx4 v252, s[8:11], s31 offen offset:2048 nt lds
  buffer_load_dwordx4 v253, s[8:11], s31 offen offset:3072 nt lds
  s_add_u32 m0, s37, 16384
  s_add_u32 s31, s30, 0
  buffer_load_dwordx4 v254, s[12:15], s31 offen offset:0 nt lds
  buffer_load_dwordx4 v254, s[12:15], s31 offen offset:1024 nt lds
  buffer_load_dwordx4 v254, s[12:15], s31 offen offset:2048 nt lds
  buffer_load_dwordx4 v254, s[12:15], s31 offen offset:3072 nt lds
  s_add_u32 m0, s37, 4096
  s_add_u32 s31, s30, 4096
  buffer_load_dwordx4 v250, s[8:11], s31 offen offset:0 nt lds
  buffer_load_dwordx4 v251, s[8:11], s31 offen offset:1024 nt lds
  buffer_load_dwordx4 v252, s[8:11], s31 offen offset:2048 nt lds
  buffer_load_dwordx4 v253, s[8:11], s31 offen offset:3072 nt lds
  s_add_u32 m0, s37, 20480
  s_add_u32 s31, s30, 4096
  buffer_load_dwordx4 v254, s[12:15], s31 offen offset:0 nt lds
  buffer_load_dwordx4 v254, s[12:15], s31 offen offset:1024 nt lds
  buffer_load_dwordx4 v254, s[12:15], s31 offen offset:2048 nt lds
  buffer_load_dwordx4 v254, s[12:15], s31 offen offset:3072 nt lds
  s_add_u32 m0, s37, 8192
  s_add_u32 s31, s30, 8192
  buffer_load_dwordx4 v250, s[8:11], s31 offen offset:0 nt lds
  buffer_load_dwordx4 v251, s[8:11], s31 offen offset:1024 nt lds
  buffer_load_dwordx4 v252, s[8:11], s31 offen offset:2048 nt lds
  buffer_load_dwordx4 v253, s[8:11], s31 offen offset:3072 nt lds
  s_add_u32 m0, s37, 24576
  s_add_u32 s31, s30, 8192
  buffer_load_dwordx4 v254, s[12:15], s31 offen offset:0 nt lds
  buffer_load_dwordx4 v254, s[12:15], s31 offen offset:1024 nt lds
  buffer_load_dwordx4 v254, s[12:15], s31 offen offset:2048 nt lds
  buffer_load_dwordx4 v254, s[12:15], s31 offen offset:3072 nt lds
  s_add_u32 m0, s37, 12288
  s_add_u32 s31, s30, 12288
  buffer_load_dwordx4 v250, s[8:11], s31 offen offset:0 nt lds
  buffer_load_dwordx4 v251, s[8:11], s31 offen offset:1024 nt lds
  buffer_load_dwordx4 v252, s[8:11], s31 offen offset:2048 nt lds
  buffer_load_dwordx4 v253, s[8:11], s31 offen offset:3072 nt lds
  s_add_u32 m0, s37, 28672
  s_add_u32 s31, s30, 12288
  buffer_load_dwordx4 v254, s[12:15], s31 offen offset:0 nt lds
  buffer_load_dwordx4 v254, s[12:15], s31 offen offset:1024 nt lds
  buffer_load_dwordx4 v254, s[12:15], s31 offen offset:2048 nt lds
  buffer_load_dwordx4 v254, s[12:15], s31 offen offset:3072 nt lds
  s_add_u32 s30, s30, 16384
  s_add_u32 s37, s37, 32768
  s_cmp_eq_u32 s37, 131072
  s_cselect_b32 s37, 0, s37
  s_sub_u32 s36, s36, 1
  s_cmp_lg_u32 s36, 0
  s_cbranch_scc1 LD_KV
  s_sub_u32 s62, s62, 1
  s_cmp_eq_u32 s62, 0
  s_cbranch_scc1 LD_TAIL
  s_xor_b32 s7, s7, 1
  s_cmp_eq_u32 s7, 0
  s_cselect_b32 s8, s46, s54
  s_cselect_b32 s9, s47, s55
  s_cselect_b32 s12, s48, s56
  s_cselect_b32 s13, s49, s57
  s_cselect_b32 s16, s50, s58
  s_cselect_b32 s17, s51, s59
  s_lshl_b32 s28, s5, 5
  s_add_u32 s28, s28, s4
  s_lshl_b32 s28, s28, 18
  s_add_u32 s8, s8, s28
  s_addc_u32 s9, s9, 0
  s_add_u32 s12, s12, s28
  s_addc_u32 s13, s13, 0
  s_lshl_b32 s28, s4, 8
  s_add_u32 s16, s16, s28
  s_addc_u32 s17, s17, 0
  s_sub_u32 s18, 0x400000, s28
  s_mul_i32 s28, s7, 56
  s_mul_i32 s29, s5, 7
  s_add_u32 s28, s28, s29
  s_add_u32 s28, s28, s3
  s_lshl_b32 s28, s28, 18
  s_lshl_b32 s29, s4, 13
  s_add_u32 s28, s28, s29
  s_add_u32 s24, s60, s28
  s_addc_u32 s25, s61, 0
  s_mov_b32 s30, 0
  s_mov_b32 s36, 4
  s_branch LD_WSTEP
LD_TAIL:
  s_waitcnt vmcnt(63)
  s_barrier
  s_load_dwordx2 s[76:77], s[0:1], 32
  s_load_dwordx2 s[78:79], s[0:1], 72
  s_and_b32 s28, s2, 127
  s_lshl_b32 s28, s28, 15
  s_cmp_ge_u32 s2, 128
  s_waitcnt lgkmcnt(0)
  s_cselect_b32 s72, s78, s76
  s_cselect_b32 s73, s79, s77
  s_add_u32 s72, s72, s28
  s_addc_u32 s73, s73, 0
  s_mov_b32 s74, 32768
  s_mov_b32 s75, 0x20000
  v_lshlrev_b32 v16, 4, v0
  s_mov_b32 s31, 0
  buffer_load_dwordx4 v[20:23], v16, s[72:75], s31 offen
  s_mov_b32 s31, 1024
  buffer_load_dwordx4 v[24:27], v16, s[72:75], s31 offen
  s_mov_b32 s31, 2048
  buffer_load_dwordx4 v[28:31], v16, s[72:75], s31 offen
  s_mov_b32 s31, 3072
  buffer_load_dwordx4 v[32:35], v16, s[72:75], s31 offen
  s_mov_b32 s31, 4096
  buffer_load_dwordx4 v[36:39], v16, s[72:75], s31 offen
  s_mov_b32 s31, 5120
  buffer_load_dwordx4 v[40:43], v16, s[72:75], s31 offen
  s_mov_b32 s31, 6144
  buffer_load_dwordx4 v[44:47], v16, s[72:75], s31 offen
  s_mov_b32 s31, 7168
  buffer_load_dwordx4 v[48:51], v16, s[72:75], s31 offen
  s_mov_b32 s31, 8192
  buffer_load_dwordx4 v[20:23], v16, s[72:75], s31 offen
  s_mov_b32 s31, 9216
  buffer_load_dwordx4 v[24:27], v16, s[72:75], s31 offen
  s_mov_b32 s31, 10240
  buffer_load_dwordx4 v[28:31], v16, s[72:75], s31 offen
  s_mov_b32 s31, 11264
  buffer_load_dwordx4 v[32:35], v16, s[72:75], s31 offen
  s_mov_b32 s31, 12288
  buffer_load_dwordx4 v[36:39], v16, s[72:75], s31 offen
  s_mov_b32 s31, 13312
  buffer_load_dwordx4 v[40:43], v16, s[72:75], s31 offen
  s_mov_b32 s31, 14336
  buffer_load_dwordx4 v[44:47], v16, s[72:75], s31 offen
  s_mov_b32 s31, 15360
  buffer_load_dwordx4 v[48:51], v16, s[72:75], s31 offen
  s_mov_b32 s31, 16384
  buffer_load_dwordx4 v[20:23], v16, s[72:75], s31 offen
  s_mov_b32 s31, 17408
  buffer_load_dwordx4 v[24:27], v16, s[72:75], s31 offen
  s_mov_b32 s31, 18432
  buffer_load_dwordx4 v[28:31], v16, s[72:75], s31 offen
  s_mov_b32 s31, 19456
  buffer_load_dwordx4 v[32:35], v16, s[72:75], s31 offen
  s_mov_b32 s31, 20480
  buffer_load_dwordx4 v[36:39], v16, s[72:75], s31 offen
  s_mov_b32 s31, 21504
  buffer_load_dwordx4 v[40:43], v16, s[72:75], s31 offen
  s_mov_b32 s31, 22528
  buffer_load_dwordx4 v[44:47], v16, s[72:75], s31 offen
  s_mov_b32 s31, 23552
  buffer_load_dwordx4 v[48:51], v16, s[72:75], s31 offen
  s_mov_b32 s31, 24576
  buffer_load_dwordx4 v[20:23], v16, s[72:75], s31 offen
  s_mov_b32 s31, 25600
  buffer_load_dwordx4 v[24:27], v16, s[72:75], s31 offen
  s_mov_b32 s31, 26624
  buffer_load_dwordx4 v[28:31], v16, s[72:75], s31 offen
  s_mov_b32 s31, 27648
  buffer_load_dwordx4 v[32:35], v16, s[72:75], s31 offen
  s_mov_b32 s31, 28672
  buffer_load_dwordx4 v[36:39], v16, s[72:75], s31 offen
  s_mov_b32 s31, 29696
  buffer_load_dwordx4 v[40:43], v16, s[72:75], s31 offen
  s_mov_b32 s31, 30720
  buffer_load_dwordx4 v[44:47], v16, s[72:75], s31 offen
  s_mov_b32 s31, 31744
  buffer_load_dwordx4 v[48:51], v16, s[72:75], s31 offen
  s_waitcnt vmcnt(63)
  s_barrier
  s_waitcnt vmcnt(32)
  s_barrier
  s_waitcnt vmcnt(0)
  s_branch DECIDE
ITEM:
  s_cmp_eq_u32 s7, 0
  s_cselect_b32 s20, s44, s52
  s_cselect_b32 s21, s45, s53
  s_mul_i32 s28, s5, 229376
  s_add_u32 s20, s20, s28
  s_addc_u32 s21, s21, 0
  s_add_u32 m0, s66, 0
  s_mov_b32 s31, 0
  buffer_load_dwordx4 v240, s[20:23], s31 offen lds
  s_add_u32 m0, s66, 1024
  s_mov_b32 s31, 8192
  buffer_load_dwordx4 v244, s[20:23], s31 offen lds
  s_add_u32 m0, s66, 2048
  s_mov_b32 s31, 16384
  buffer_load_dwordx4 v240, s[20:23], s31 offen lds
  s_add_u32 m0, s66, 3072
  s_mov_b32 s31, 24576
  buffer_load_dwordx4 v244, s[20:23], s31 offen lds
  s_waitcnt vmcnt(0)
ITEM2:
  s_cmp_eq_u32 s7, 0
  s_cselect_b32 s8, s46, s54
  s_cselect_b32 s9, s47, s55
  s_cselect_b32 s12, s48, s56
  s_cselect_b32 s13, s49, s57
  s_cselect_b32 s16, s50, s58
  s_cselect_b32 s17, s51, s59
  s_lshl_b32 s28, s5, 5
  s_add_u32 s28, s28, s4
  s_lshl_b32 s28, s28, 18
  s_add_u32 s8, s8, s28
  s_addc_u32 s9, s9, 0
  s_add_u32 s12, s12, s28
  s_addc_u32 s13, s13, 0
  s_lshl_b32 s28, s4, 8
  s_add_u32 s16, s16, s28
  s_addc_u32 s17, s17, 0
  s_sub_u32 s18, 0x400000, s28
  s_mul_i32 s28, s7, 56
  s_mul_i32 s29, s5, 7
  s_add_u32 s28, s28, s29
  s_add_u32 s28, s28, s3
  s_lshl_b32 s28, s28, 18
  s_lshl_b32 s29, s4, 13
  s_add_u32 s28, s28, s29
  s_add_u32 s24, s60, s28
  s_addc_u32 s25, s61, 0
ITEM_X:
  s_waitcnt lgkmcnt(0)
  s_nop 13
  s_barrier
  ds_read_b64_tr_b16 v[144:145], v10 offset:0
  ds_read_b64_tr_b16 v[146:147], v10 offset:2048
  ds_read_b64_tr_b16 v[148:149], v11 offset:0
  ds_read_b64_tr_b16 v[150:151], v11 offset:2048
  ds_read_b64_tr_b16 v[152:153], v12 offset:0
  ds_read_b64_tr_b16 v[154:155], v12 offset:2048
  ds_read_b64_tr_b16 v[156:157], v13 offset:0
  ds_read_b64_tr_b16 v[158:159], v13 offset:2048
  s_waitcnt vmcnt(8)
  ds_read_b128 v[112:115], v245
  ds_read_b128 v[116:119], v246
  ds_read_b128 v[120:123], v247
  ds_read_b128 v[124:127], v248
  s_waitcnt lgkmcnt(0)
  s_add_u32 m0, s66, 0
  s_mov_b32 s31, 128
  buffer_load_dwordx4 v240, s[20:23], s31 offen lds
  s_add_u32 m0, s66, 1024
  s_mov_b32 s31, 8320
  buffer_load_dwordx4 v244, s[20:23], s31 offen lds
  s_add_u32 m0, s66, 2048
  s_mov_b32 s31, 16512
  buffer_load_dwordx4 v240, s[20:23], s31 offen lds
  s_add_u32 m0, s66, 3072
  s_mov_b32 s31, 24704
  buffer_load_dwordx4 v244, s[20:23], s31 offen lds
  v_mfma_f32_32x32x16_bf16 v[16:31], v[144:147], v[112:115], 0
  ds_read_b64_tr_b16 v[160:161], v10 offset:4096
  ds_read_b64_tr_b16 v[162:163], v10 offset:6144
  v_mfma_f32_32x32x16_bf16 v[32:47], v[148:151], v[112:115], 0
  ds_read_b64_tr_b16 v[164:165], v11 offset:4096
  ds_read_b64_tr_b16 v[166:167], v11 offset:6144
  v_mfma_f32_32x32x16_bf16 v[48:63], v[152:155], v[112:115], 0
  ds_read_b64_tr_b16 v[168:169], v12 offset:4096
  ds_read_b64_tr_b16 v[170:171], v12 offset:6144
  v_mfma_f32_32x32x16_bf16 v[64:79], v[156:159], v[112:115], 0
  ds_read_b64_tr_b16 v[172:173], v13 offset:4096
  ds_read_b64_tr_b16 v[174:175], v13 offset:6144
  s_waitcnt lgkmcnt(6)
  v_mfma_f32_32x32x16_bf16 v[16:31], v[160:163], v[116:119], v[16:31]
  ds_read_b64_tr_b16 v[144:145], v10 offset:8192
  ds_read_b64_tr_b16 v[146:147], v10 offset:10240
  s_waitcnt lgkmcnt(6)
  v_mfma_f32_32x32x16_bf16 v[32:47], v[164:167], v[116:119], v[32:47]
  ds_read_b64_tr_b16 v[148:149], v11 offset:8192
  ds_read_b64_tr_b16 v[150:151], v11 offset:10240
  s_waitcnt lgkmcnt(6)
  v_mfma_f32_32x32x16_bf16 v[48:63], v[168:171], v[116:119], v[48:63]
  ds_read_b64_tr_b16 v[152:153], v12 offset:8192
  ds_read_b64_tr_b16 v[154:155], v12 offset:10240
  s_waitcnt lgkmcnt(6)
  v_mfma_f32_32x32x16_bf16 v[64:79], v[172:175], v[116:119], v[64:79]
  ds_read_b64_tr_b16 v[156:157], v13 offset:8192
  ds_read_b64_tr_b16 v[158:159], v13 offset:10240
  s_waitcnt lgkmcnt(6)
  v_mfma_f32_32x32x16_bf16 v[16:31], v[144:147], v[120:123], v[16:31]
  ds_read_b64_tr_b16 v[160:161], v10 offset:12288
  ds_read_b64_tr_b16 v[162:163], v10 offset:14336
  s_waitcnt lgkmcnt(6)
  v_mfma_f32_32x32x16_bf16 v[32:47], v[148:151], v[120:123], v[32:47]
  ds_read_b64_tr_b16 v[164:165], v11 offset:12288
  ds_read_b64_tr_b16 v[166:167], v11 offset:14336
  s_waitcnt lgkmcnt(6)
  v_mfma_f32_32x32x16_bf16 v[48:63], v[152:155], v[120:123], v[48:63]
  ds_read_b64_tr_b16 v[168:169], v12 offset:12288
  ds_read_b64_tr_b16 v[170:171], v12 offset:14336
  s_waitcnt lgkmcnt(6)
  v_mfma_f32_32x32x16_bf16 v[64:79], v[156:159], v[120:123], v[64:79]
  ds_read_b64_tr_b16 v[172:173], v13 offset:12288
  ds_read_b64_tr_b16 v[174:175], v13 offset:14336
  s_waitcnt vmcnt(0)
  ds_read_b128 v[128:131], v245
  ds_read_b128 v[132:135], v246
  ds_read_b128 v[136:139], v247
  ds_read_b128 v[140:143], v248
  s_waitcnt lgkmcnt(10)
  v_mfma_f32_32x32x16_bf16 v[16:31], v[160:163], v[124:127], v[16:31]
  ds_read_b64_tr_b16 v[144:145], v10 offset:16384
  ds_read_b64_tr_b16 v[146:147], v10 offset:18432
  s_waitcnt lgkmcnt(10)
  v_mfma_f32_32x32x16_bf16 v[32:47], v[164:167], v[124:127], v[32:47]
  ds_read_b64_tr_b16 v[148:149], v11 offset:16384
  ds_read_b64_tr_b16 v[150:151], v11 offset:18432
  s_waitcnt lgkmcnt(0)
  s_add_u32 m0, s66, 0
  s_mov_b32 s31, 256
  buffer_load_dwordx4 v240, s[20:23], s31 offen lds
  s_add_u32 m0, s66, 1024
  s_mov_b32 s31, 8448
  buffer_load_dwordx4 v244, s[20:23], s31 offen lds
  s_add_u32 m0, s66, 2048
  s_mov_b32 s31, 16640
  buffer_load_dwordx4 v240, s[20:23], s31 offen lds
  s_add_u32 m0, s66, 3072
  s_mov_b32 s31, 24832
  buffer_load_dwordx4 v244, s[20:23], s31 offen lds
  v_mfma_f32_32x32x16_bf16 v[48:63], v[168:171], v[124:127], v[48:63]
  ds_read_b64_tr_b16 v[152:153], v12 offset:16384
  ds_read_b64_tr_b16 v[154:155], v12 offset:18432
  v_mfma_f32_32x32x16_bf16 v[64:79], v[172:175], v[124:127], v[64:79]
  ds_read_b64_tr_b16 v[156:157], v13 offset:16384
  ds_read_b64_tr_b16 v[158:159], v13 offset:18432
  v_mfma_f32_32x32x16_bf16 v[16:31], v[144:147], v[128:131], v[16:31]
  ds_read_b64_tr_b16 v[160:161], v10 offset:20480
  ds_read_b64_tr_b16 v[162:163], v10 offset:22528
  v_mfma_f32_32x32x16_bf16 v[32:47], v[148:151], v[128:131], v[32:47]
  ds_read_b64_tr_b16 v[164:165], v11 offset:20480
  ds_read_b64_tr_b16 v[166:167], v11 offset:22528
  s_waitcnt lgkmcnt(6)
  v_mfma_f32_32x32x16_bf16 v[48:63], v[152:155], v[128:131], v[48:63]
  ds_read_b64_tr_b16 v[168:169], v12 offset:20480
  ds_read_b64_tr_b16 v[170:171], v12 offset:22528
  s_waitcnt lgkmcnt(6)
  v_mfma_f32_32x32x16_bf16 v[64:79], v[156:159], v[128:131], v[64:79]
  ds_read_b64_tr_b16 v[172:173], v13 offset:20480
  ds_read_b64_tr_b16 v[174:175], v13 offset:22528
  s_waitcnt lgkmcnt(6)
  v_mfma_f32_32x32x16_bf16 v[16:31], v[160:163], v[132:135], v[16:31]
  ds_read_b64_tr_b16 v[144:145], v10 offset:24576
  ds_read_b64_tr_b16 v[146:147], v10 offset:26624
  s_waitcnt lgkmcnt(6)
  v_mfma_f32_32x32x16_bf16 v[32:47], v[164:167], v[132:135], v[32:47]
  ds_read_b64_tr_b16 v[148:149], v11 offset:24576
  ds_read_b64_tr_b16 v[150:151], v11 offset:26624
  s_waitcnt lgkmcnt(6)
  v_mfma_f32_32x32x16_bf16 v[48:63], v[168:171], v[132:135], v[48:63]
  ds_read_b64_tr_b16 v[152:153], v12 offset:24576
  ds_read_b64_tr_b16 v[154:155], v12 offset:26624
  s_waitcnt lgkmcnt(6)
  v_mfma_f32_32x32x16_bf16 v[64:79], v[172:175], v[132:135], v[64:79]
  ds_read_b64_tr_b16 v[156:157], v13 offset:24576
  ds_read_b64_tr_b16 v[158:159], v13 offset:26624
  s_waitcnt lgkmcnt(6)
  v_mfma_f32_32x32x16_bf16 v[16:31], v[144:147], v[136:139], v[16:31]
  ds_read_b64_tr_b16 v[160:161], v10 offset:28672
  ds_read_b64_tr_b16 v[162:163], v10 offset:30720
  s_waitcnt lgkmcnt(6)
  v_mfma_f32_32x32x16_bf16 v[32:47], v[148:151], v[136:139], v[32:47]
  ds_read_b64_tr_b16 v[164:165], v11 offset:28672
  ds_read_b64_tr_b16 v[166:167], v11 offset:30720
  s_waitcnt lgkmcnt(6)
  v_mfma_f32_32x32x16_bf16 v[48:63], v[152:155], v[136:139], v[48:63]
  ds_read_b64_tr_b16 v[168:169], v12 offset:28672
  ds_read_b64_tr_b16 v[170:171], v12 offset:30720
  s_waitcnt lgkmcnt(6)
  v_mfma_f32_32x32x16_bf16 v[64:79], v[156:159], v[136:139], v[64:79]
  ds_read_b64_tr_b16 v[172:173], v13 offset:28672
  ds_read_b64_tr_b16 v[174:175], v13 offset:30720
  s_waitcnt vmcnt(0)
  ds_read_b128 v[112:115], v245
  ds_read_b128 v[116:119], v246
  ds_read_b128 v[120:123], v247
  ds_read_b128 v[124:127], v248
  s_waitcnt lgkmcnt(10)
  v_mfma_f32_32x32x16_bf16 v[16:31], v[160:163], v[140:143], v[16:31]
  s_waitcnt lgkmcnt(8)
  v_mfma_f32_32x32x16_bf16 v[32:47], v[164:167], v[140:143], v[32:47]
  s_waitcnt lgkmcnt(0)
  s_add_u32 m0, s66, 0
  s_mov_b32 s31, 384
  buffer_load_dwordx4 v240, s[20:23], s31 offen lds
  s_add_u32 m0, s66, 1024
  s_mov_b32 s31, 8576
  buffer_load_dwordx4 v244, s[20:23], s31 offen lds
  s_add_u32 m0, s66, 2048
  s_mov_b32 s31, 16768
  buffer_load_dwordx4 v240, s[20:23], s31 offen lds
  s_add_u32 m0, s66, 3072
  s_mov_b32 s31, 24960
  buffer_load_dwordx4 v244, s[20:23], s31 offen lds
  v_mfma_f32_32x32x16_bf16 v[48:63], v[168:171], v[140:143], v[48:63]
  v_mfma_f32_32x32x16_bf16 v[64:79], v[172:175], v[140:143], v[64:79]
  s_add_u32 s39, s37, 32768
  s_cmp_eq_u32 s39, 131072
  s_cselect_b32 s39, 0, s39
  s_sub_u32 s29, s39, s37
  s_mov_b32 s37, s39
  s_mov_b32 s39, s29
  v_add_u32 v2, s39, v2
  v_add_u32 v3, s39, v3
  v_add_u32 v4, s39, v4
  v_add_u32 v5, s39, v5
  v_add_u32 v6, s39, v6
  v_add_u32 v7, s39, v7
  v_add_u32 v8, s39, v8
  v_add_u32 v9, s39, v9
  v_add_u32 v10, s39, v10
  v_add_u32 v11, s39, v11
  v_add_u32 v12, s39, v12
  v_add_u32 v13, s39, v13
  s_barrier
  ds_read_b64_tr_b16 v[144:145], v10 offset:0
  ds_read_b64_tr_b16 v[146:147], v10 offset:2048
  ds_read_b64_tr_b16 v[148:149], v11 offset:0
  ds_read_b64_tr_b16 v[150:151], v11 offset:2048
  ds_read_b64_tr_b16 v[152:153], v12 offset:0
  ds_read_b64_tr_b16 v[154:155], v12 offset:2048
  ds_read_b64_tr_b16 v[156:157], v13 offset:0
  ds_read_b64_tr_b16 v[158:159], v13 offset:2048
  s_waitcnt lgkmcnt(6)
  v_mfma_f32_32x32x16_bf16 v[16:31], v[144:147], v[112:115], v[16:31]
  ds_read_b64_tr_b16 v[160:161], v10 offset:4096
  ds_read_b64_tr_b16 v[162:163], v10 offset:6144
  s_waitcnt lgkmcnt(6)
  v_mfma_f32_32x32x16_bf16 v[32:47], v[148:151], v[112:115], v[32:47]
  ds_read_b64_tr_b16 v[164:165], v11 offset:4096
  ds_read_b64_tr_b16 v[166:167], v11 offset:6144
  s_waitcnt lgkmcnt(6)
  v_mfma_f32_32x32x16_bf16 v[48:63], v[152:155], v[112:115], v[48:63]
  ds_read_b64_tr_b16 v[168:169], v12 offset:4096
  ds_read_b64_tr_b16 v[170:171], v12 offset:6144
  s_waitcnt lgkmcnt(6)
  v_mfma_f32_32x32x16_bf16 v[64:79], v[156:159], v[112:115], v[64:79]
  ds_read_b64_tr_b16 v[172:173], v13 offset:4096
  ds_read_b64_tr_b16 v[174:175], v13 offset:6144
  s_waitcnt lgkmcnt(6)
  v_mfma_f32_32x32x16_bf16 v[16:31], v[160:163], v[116:119], v[16:31]
  ds_read_b64_tr_b16 v[144:145], v10 offset:8192
  ds_read_b64_tr_b16 v[146:147], v10 offset:10240
  s_waitcnt lgkmcnt(6)
  v_mfma_f32_32x32x16_bf16 v[32:47], v[164:167], v[116:119], v[32:47]
  ds_read_b64_tr_b16 v[148:149], v11 offset:8192
  ds_read_b64_tr_b16 v[150:151], v11 offset:10240
  s_waitcnt lgkmcnt(6)
  v_mfma_f32_32x32x16_bf16 v[48:63], v[168:171], v[116:119], v[48:63]
  ds_read_b64_tr_b16 v[152:153], v12 offset:8192
  ds_read_b64_tr_b16 v[154:155], v12 offset:10240
  s_waitcnt lgkmcnt(6)
  v_mfma_f32_32x32x16_bf16 v[64:79], v[172:175], v[116:119], v[64:79]
  ds_read_b64_tr_b16 v[156:157], v13 offset:8192
  ds_read_b64_tr_b16 v[158:159], v13 offset:10240
  s_waitcnt lgkmcnt(6)
  v_mfma_f32_32x32x16_bf16 v[16:31], v[144:147], v[120:123], v[16:31]
  ds_read_b64_tr_b16 v[160:161], v10 offset:12288
  ds_read_b64_tr_b16 v[162:163], v10 offset:14336
  s_waitcnt lgkmcnt(6)
  v_mfma_f32_32x32x16_bf16 v[32:47], v[148:151], v[120:123], v[32:47]
  ds_read_b64_tr_b16 v[164:165], v11 offset:12288
  ds_read_b64_tr_b16 v[166:167], v11 offset:14336
  s_waitcnt lgkmcnt(6)
  v_mfma_f32_32x32x16_bf16 v[48:63], v[152:155], v[120:123], v[48:63]
  ds_read_b64_tr_b16 v[168:169], v12 offset:12288
  ds_read_b64_tr_b16 v[170:171], v12 offset:14336
  s_waitcnt lgkmcnt(6)
  v_mfma_f32_32x32x16_bf16 v[64:79], v[156:159], v[120:123], v[64:79]
  ds_read_b64_tr_b16 v[172:173], v13 offset:12288
  ds_read_b64_tr_b16 v[174:175], v13 offset:14336
  s_waitcnt vmcnt(0)
  ds_read_b128 v[128:131], v245
  ds_read_b128 v[132:135], v246
  ds_read_b128 v[136:139], v247
  ds_read_b128 v[140:143], v248
  s_waitcnt lgkmcnt(10)
  v_mfma_f32_32x32x16_bf16 v[16:31], v[160:163], v[124:127], v[16:31]
  ds_read_b64_tr_b16 v[144:145], v10 offset:16384
  ds_read_b64_tr_b16 v[146:147], v10 offset:18432
  s_waitcnt lgkmcnt(10)
  v_mfma_f32_32x32x16_bf16 v[32:47], v[164:167], v[124:127], v[32:47]
  ds_read_b64_tr_b16 v[148:149], v11 offset:16384
  ds_read_b64_tr_b16 v[150:151], v11 offset:18432
  s_waitcnt lgkmcnt(0)
  s_add_u32 m0, s66, 0
  s_mov_b32 s31, 512
  buffer_load_dwordx4 v240, s[20:23], s31 offen lds
  s_add_u32 m0, s66, 1024
  s_mov_b32 s31, 8704
  buffer_load_dwordx4 v244, s[20:23], s31 offen lds
  s_add_u32 m0, s66, 2048
  s_mov_b32 s31, 16896
  buffer_load_dwordx4 v240, s[20:23], s31 offen lds
  s_add_u32 m0, s66, 3072
  s_mov_b32 s31, 25088
  buffer_load_dwordx4 v244, s[20:23], s31 offen lds
  v_mfma_f32_32x32x16_bf16 v[48:63], v[168:171], v[124:127], v[48:63]
  ds_read_b64_tr_b16 v[152:153], v12 offset:16384
  ds_read_b64_tr_b16 v[154:155], v12 offset:18432
  v_mfma_f32_32x32x16_bf16 v[64:79], v[172:175], v[124:127], v[64:79]
  ds_read_b64_tr_b16 v[156:157], v13 offset:16384
  ds_read_b64_tr_b16 v[158:159], v13 offset:18432
  v_mfma_f32_32x32x16_bf16 v[16:31], v[144:147], v[128:131], v[16:31]
  ds_read_b64_tr_b16 v[160:161], v10 offset:20480
  ds_read_b64_tr_b16 v[162:163], v10 offset:22528
  v_mfma_f32_32x32x16_bf16 v[32:47], v[148:151], v[128:131], v[32:47]
  ds_read_b64_tr_b16 v[164:165], v11 offset:20480
  ds_read_b64_tr_b16 v[166:167], v11 offset:22528
  s_waitcnt lgkmcnt(6)
  v_mfma_f32_32x32x16_bf16 v[48:63], v[152:155], v[128:131], v[48:63]
  ds_read_b64_tr_b16 v[168:169], v12 offset:20480
  ds_read_b64_tr_b16 v[170:171], v12 offset:22528
  s_waitcnt lgkmcnt(6)
  v_mfma_f32_32x32x16_bf16 v[64:79], v[156:159], v[128:131], v[64:79]
  ds_read_b64_tr_b16 v[172:173], v13 offset:20480
  ds_read_b64_tr_b16 v[174:175], v13 offset:22528
  s_waitcnt lgkmcnt(6)
  v_mfma_f32_32x32x16_bf16 v[16:31], v[160:163], v[132:135], v[16:31]
  ds_read_b64_tr_b16 v[144:145], v10 offset:24576
  ds_read_b64_tr_b16 v[146:147], v10 offset:26624
  s_waitcnt lgkmcnt(6)
  v_mfma_f32_32x32x16_bf16 v[32:47], v[164:167], v[132:135], v[32:47]
  ds_read_b64_tr_b16 v[148:149], v11 offset:24576
  ds_read_b64_tr_b16 v[150:151], v11 offset:26624
  s_waitcnt lgkmcnt(6)
  v_mfma_f32_32x32x16_bf16 v[48:63], v[168:171], v[132:135], v[48:63]
  ds_read_b64_tr_b16 v[152:153], v12 offset:24576
  ds_read_b64_tr_b16 v[154:155], v12 offset:26624
  s_waitcnt lgkmcnt(6)
  v_mfma_f32_32x32x16_bf16 v[64:79], v[172:175], v[132:135], v[64:79]
  ds_read_b64_tr_b16 v[156:157], v13 offset:24576
  ds_read_b64_tr_b16 v[158:159], v13 offset:26624
  s_waitcnt lgkmcnt(6)
  v_mfma_f32_32x32x16_bf16 v[16:31], v[144:147], v[136:139], v[16:31]
  ds_read_b64_tr_b16 v[160:161], v10 offset:28672
  ds_read_b64_tr_b16 v[162:163], v10 offset:30720
  s_waitcnt lgkmcnt(6)
  v_mfma_f32_32x32x16_bf16 v[32:47], v[148:151], v[136:139], v[32:47]
  ds_read_b64_tr_b16 v[164:165], v11 offset:28672
  ds_read_b64_tr_b16 v[166:167], v11 offset:30720
  s_waitcnt lgkmcnt(6)
  v_mfma_f32_32x32x16_bf16 v[48:63], v[152:155], v[136:139], v[48:63]
  ds_read_b64_tr_b16 v[168:169], v12 offset:28672
  ds_read_b64_tr_b16 v[170:171], v12 offset:30720
  s_waitcnt lgkmcnt(6)
  v_mfma_f32_32x32x16_bf16 v[64:79], v[156:159], v[136:139], v[64:79]
  ds_read_b64_tr_b16 v[172:173], v13 offset:28672
  ds_read_b64_tr_b16 v[174:175], v13 offset:30720
  s_waitcnt vmcnt(0)
  ds_read_b128 v[112:115], v245
  ds_read_b128 v[116:119], v246
  ds_read_b128 v[120:123], v247
  ds_read_b128 v[124:127], v248
  s_waitcnt lgkmcnt(10)
  v_mfma_f32_32x32x16_bf16 v[16:31], v[160:163], v[140:143], v[16:31]
  s_waitcnt lgkmcnt(8)
  v_mfma_f32_32x32x16_bf16 v[32:47], v[164:167], v[140:143], v[32:47]
  s_waitcnt lgkmcnt(0)
  s_add_u32 m0, s66, 0
  s_mov_b32 s31, 640
  buffer_load_dwordx4 v240, s[20:23], s31 offen lds
  s_add_u32 m0, s66, 1024
  s_mov_b32 s31, 8832
  buffer_load_dwordx4 v244, s[20:23], s31 offen lds
  s_add_u32 m0, s66, 2048
  s_mov_b32 s31, 17024
  buffer_load_dwordx4 v240, s[20:23], s31 offen lds
  s_add_u32 m0, s66, 3072
  s_mov_b32 s31, 25216
  buffer_load_dwordx4 v244, s[20:23], s31 offen lds
  v_mfma_f32_32x32x16_bf16 v[48:63], v[168:171], v[140:143], v[48:63]
  v_mfma_f32_32x32x16_bf16 v[64:79], v[172:175], v[140:143], v[64:79]
  s_add_u32 s39, s37, 32768
  s_cmp_eq_u32 s39, 131072
  s_cselect_b32 s39, 0, s39
  s_sub_u32 s29, s39, s37
  s_mov_b32 s37, s39
  s_mov_b32 s39, s29
  v_add_u32 v2, s39, v2
  v_add_u32 v3, s39, v3
  v_add_u32 v4, s39, v4
  v_add_u32 v5, s39, v5
  v_add_u32 v6, s39, v6
  v_add_u32 v7, s39, v7
  v_add_u32 v8, s39, v8
  v_add_u32 v9, s39, v9
  v_add_u32 v10, s39, v10
  v_add_u32 v11, s39, v11
  v_add_u32 v12, s39, v12
  v_add_u32 v13, s39, v13
  s_barrier
  ds_read_b64_tr_b16 v[144:145], v10 offset:0
  ds_read_b64_tr_b16 v[146:147], v10 offset:2048
  ds_read_b64_tr_b16 v[148:149], v11 offset:0
  ds_read_b64_tr_b16 v[150:151], v11 offset:2048
  ds_read_b64_tr_b16 v[152:153], v12 offset:0
  ds_read_b64_tr_b16 v[154:155], v12 offset:2048
  ds_read_b64_tr_b16 v[156:157], v13 offset:0
  ds_read_b64_tr_b16 v[158:159], v13 offset:2048
  s_waitcnt lgkmcnt(6)
  v_mfma_f32_32x32x16_bf16 v[16:31], v[144:147], v[112:115], v[16:31]
  ds_read_b64_tr_b16 v[160:161], v10 offset:4096
  ds_read_b64_tr_b16 v[162:163], v10 offset:6144
  s_waitcnt lgkmcnt(6)
  v_mfma_f32_32x32x16_bf16 v[32:47], v[148:151], v[112:115], v[32:47]
  ds_read_b64_tr_b16 v[164:165], v11 offset:4096
  ds_read_b64_tr_b16 v[166:167], v11 offset:6144
  s_waitcnt lgkmcnt(6)
  v_mfma_f32_32x32x16_bf16 v[48:63], v[152:155], v[112:115], v[48:63]
  ds_read_b64_tr_b16 v[168:169], v12 offset:4096
  ds_read_b64_tr_b16 v[170:171], v12 offset:6144
  s_waitcnt lgkmcnt(6)
  v_mfma_f32_32x32x16_bf16 v[64:79], v[156:159], v[112:115], v[64:79]
  ds_read_b64_tr_b16 v[172:173], v13 offset:4096
  ds_read_b64_tr_b16 v[174:175], v13 offset:6144
  s_waitcnt lgkmcnt(6)
  v_mfma_f32_32x32x16_bf16 v[16:31], v[160:163], v[116:119], v[16:31]
  ds_read_b64_tr_b16 v[144:145], v10 offset:8192
  ds_read_b64_tr_b16 v[146:147], v10 offset:10240
  s_waitcnt lgkmcnt(6)
  v_mfma_f32_32x32x16_bf16 v[32:47], v[164:167], v[116:119], v[32:47]
  ds_read_b64_tr_b16 v[148:149], v11 offset:8192
  ds_read_b64_tr_b16 v[150:151], v11 offset:10240
  s_waitcnt lgkmcnt(6)
  v_mfma_f32_32x32x16_bf16 v[48:63], v[168:171], v[116:119], v[48:63]
  ds_read_b64_tr_b16 v[152:153], v12 offset:8192
  ds_read_b64_tr_b16 v[154:155], v12 offset:10240
  s_waitcnt lgkmcnt(6)
  v_mfma_f32_32x32x16_bf16 v[64:79], v[172:175], v[116:119], v[64:79]
  ds_read_b64_tr_b16 v[156:157], v13 offset:8192
  ds_read_b64_tr_b16 v[158:159], v13 offset:10240
  s_waitcnt lgkmcnt(6)
  v_mfma_f32_32x32x16_bf16 v[16:31], v[144:147], v[120:123], v[16:31]
  ds_read_b64_tr_b16 v[160:161], v10 offset:12288
  ds_read_b64_tr_b16 v[162:163], v10 offset:14336
  s_waitcnt lgkmcnt(6)
  v_mfma_f32_32x32x16_bf16 v[32:47], v[148:151], v[120:123], v[32:47]
  ds_read_b64_tr_b16 v[164:165], v11 offset:12288
  ds_read_b64_tr_b16 v[166:167], v11 offset:14336
  s_waitcnt lgkmcnt(6)
  v_mfma_f32_32x32x16_bf16 v[48:63], v[152:155], v[120:123], v[48:63]
  ds_read_b64_tr_b16 v[168:169], v12 offset:12288
  ds_read_b64_tr_b16 v[170:171], v12 offset:14336
  s_waitcnt lgkmcnt(6)
  v_mfma_f32_32x32x16_bf16 v[64:79], v[156:159], v[120:123], v[64:79]
  ds_read_b64_tr_b16 v[172:173], v13 offset:12288
  ds_read_b64_tr_b16 v[174:175], v13 offset:14336
  s_waitcnt vmcnt(0)
  ds_read_b128 v[128:131], v245
  ds_read_b128 v[132:135], v246
  ds_read_b128 v[136:139], v247
  ds_read_b128 v[140:143], v248
  s_waitcnt lgkmcnt(10)
  v_mfma_f32_32x32x16_bf16 v[16:31], v[160:163], v[124:127], v[16:31]
  ds_read_b64_tr_b16 v[144:145], v10 offset:16384
  ds_read_b64_tr_b16 v[146:147], v10 offset:18432
  s_waitcnt lgkmcnt(10)
  v_mfma_f32_32x32x16_bf16 v[32:47], v[164:167], v[124:127], v[32:47]
  ds_read_b64_tr_b16 v[148:149], v11 offset:16384
  ds_read_b64_tr_b16 v[150:151], v11 offset:18432
  s_waitcnt lgkmcnt(0)
  s_add_u32 m0, s66, 0
  s_mov_b32 s31, 768
  buffer_load_dwordx4 v240, s[20:23], s31 offen lds
  s_add_u32 m0, s66, 1024
  s_mov_b32 s31, 8960
  buffer_load_dwordx4 v244, s[20:23], s31 offen lds
  s_add_u32 m0, s66, 2048
  s_mov_b32 s31, 17152
  buffer_load_dwordx4 v240, s[20:23], s31 offen lds
  s_add_u32 m0, s66, 3072
  s_mov_b32 s31, 25344
  buffer_load_dwordx4 v244, s[20:23], s31 offen lds
  v_mfma_f32_32x32x16_bf16 v[48:63], v[168:171], v[124:127], v[48:63]
  ds_read_b64_tr_b16 v[152:153], v12 offset:16384
  ds_read_b64_tr_b16 v[154:155], v12 offset:18432
  v_mfma_f32_32x32x16_bf16 v[64:79], v[172:175], v[124:127], v[64:79]
  ds_read_b64_tr_b16 v[156:157], v13 offset:16384
  ds_read_b64_tr_b16 v[158:159], v13 offset:18432
  v_mfma_f32_32x32x16_bf16 v[16:31], v[144:147], v[128:131], v[16:31]
  ds_read_b64_tr_b16 v[160:161], v10 offset:20480
  ds_read_b64_tr_b16 v[162:163], v10 offset:22528
  v_mfma_f32_32x32x16_bf16 v[32:47], v[148:151], v[128:131], v[32:47]
  ds_read_b64_tr_b16 v[164:165], v11 offset:20480
  ds_read_b64_tr_b16 v[166:167], v11 offset:22528
  s_waitcnt lgkmcnt(6)
  v_mfma_f32_32x32x16_bf16 v[48:63], v[152:155], v[128:131], v[48:63]
  ds_read_b64_tr_b16 v[168:169], v12 offset:20480
  ds_read_b64_tr_b16 v[170:171], v12 offset:22528
  s_waitcnt lgkmcnt(6)
  v_mfma_f32_32x32x16_bf16 v[64:79], v[156:159], v[128:131], v[64:79]
  ds_read_b64_tr_b16 v[172:173], v13 offset:20480
  ds_read_b64_tr_b16 v[174:175], v13 offset:22528
  s_waitcnt lgkmcnt(6)
  v_mfma_f32_32x32x16_bf16 v[16:31], v[160:163], v[132:135], v[16:31]
  ds_read_b64_tr_b16 v[144:145], v10 offset:24576
  ds_read_b64_tr_b16 v[146:147], v10 offset:26624
  s_waitcnt lgkmcnt(6)
  v_mfma_f32_32x32x16_bf16 v[32:47], v[164:167], v[132:135], v[32:47]
  ds_read_b64_tr_b16 v[148:149], v11 offset:24576
  ds_read_b64_tr_b16 v[150:151], v11 offset:26624
  s_waitcnt lgkmcnt(6)
  v_mfma_f32_32x32x16_bf16 v[48:63], v[168:171], v[132:135], v[48:63]
  ds_read_b64_tr_b16 v[152:153], v12 offset:24576
  ds_read_b64_tr_b16 v[154:155], v12 offset:26624
  s_waitcnt lgkmcnt(6)
  v_mfma_f32_32x32x16_bf16 v[64:79], v[172:175], v[132:135], v[64:79]
  ds_read_b64_tr_b16 v[156:157], v13 offset:24576
  ds_read_b64_tr_b16 v[158:159], v13 offset:26624
  s_waitcnt lgkmcnt(6)
  v_mfma_f32_32x32x16_bf16 v[16:31], v[144:147], v[136:139], v[16:31]
  ds_read_b64_tr_b16 v[160:161], v10 offset:28672
  ds_read_b64_tr_b16 v[162:163], v10 offset:30720
  s_waitcnt lgkmcnt(6)
  v_mfma_f32_32x32x16_bf16 v[32:47], v[148:151], v[136:139], v[32:47]
  ds_read_b64_tr_b16 v[164:165], v11 offset:28672
  ds_read_b64_tr_b16 v[166:167], v11 offset:30720
  s_waitcnt lgkmcnt(6)
  v_mfma_f32_32x32x16_bf16 v[48:63], v[152:155], v[136:139], v[48:63]
  ds_read_b64_tr_b16 v[168:169], v12 offset:28672
  ds_read_b64_tr_b16 v[170:171], v12 offset:30720
  s_waitcnt lgkmcnt(6)
  v_mfma_f32_32x32x16_bf16 v[64:79], v[156:159], v[136:139], v[64:79]
  ds_read_b64_tr_b16 v[172:173], v13 offset:28672
  ds_read_b64_tr_b16 v[174:175], v13 offset:30720
  s_waitcnt vmcnt(0)
  ds_read_b128 v[112:115], v245
  ds_read_b128 v[116:119], v246
  ds_read_b128 v[120:123], v247
  ds_read_b128 v[124:127], v248
  s_waitcnt lgkmcnt(10)
  v_mfma_f32_32x32x16_bf16 v[16:31], v[160:163], v[140:143], v[16:31]
  s_waitcnt lgkmcnt(8)
  v_mfma_f32_32x32x16_bf16 v[32:47], v[164:167], v[140:143], v[32:47]
  s_waitcnt lgkmcnt(0)
  s_add_u32 m0, s66, 0
  s_mov_b32 s31, 896
  buffer_load_dwordx4 v240, s[20:23], s31 offen lds
  s_add_u32 m0, s66, 1024
  s_mov_b32 s31, 9088
  buffer_load_dwordx4 v244, s[20:23], s31 offen lds
  s_add_u32 m0, s66, 2048
  s_mov_b32 s31, 17280
  buffer_load_dwordx4 v240, s[20:23], s31 offen lds
  s_add_u32 m0, s66, 3072
  s_mov_b32 s31, 25472
  buffer_load_dwordx4 v244, s[20:23], s31 offen lds
  v_mfma_f32_32x32x16_bf16 v[48:63], v[168:171], v[140:143], v[48:63]
  v_mfma_f32_32x32x16_bf16 v[64:79], v[172:175], v[140:143], v[64:79]
  s_add_u32 s39, s37, 32768
  s_cmp_eq_u32 s39, 131072
  s_cselect_b32 s39, 0, s39
  s_sub_u32 s29, s39, s37
  s_mov_b32 s37, s39
  s_mov_b32 s39, s29
  v_add_u32 v2, s39, v2
  v_add_u32 v3, s39, v3
  v_add_u32 v4, s39, v4
  v_add_u32 v5, s39, v5
  v_add_u32 v6, s39, v6
  v_add_u32 v7, s39, v7
  v_add_u32 v8, s39, v8
  v_add_u32 v9, s39, v9
  v_add_u32 v10, s39, v10
  v_add_u32 v11, s39, v11
  v_add_u32 v12, s39, v12
  v_add_u32 v13, s39, v13
  s_barrier
  ds_read_b64_tr_b16 v[144:145], v10 offset:0
  ds_read_b64_tr_b16 v[146:147], v10 offset:2048
  ds_read_b64_tr_b16 v[148:149], v11 offset:0
  ds_read_b64_tr_b16 v[150:151], v11 offset:2048
  ds_read_b64_tr_b16 v[152:153], v12 offset:0
  ds_read_b64_tr_b16 v[154:155], v12 offset:2048
  ds_read_b64_tr_b16 v[156:157], v13 offset:0
  ds_read_b64_tr_b16 v[158:159], v13 offset:2048
  s_waitcnt lgkmcnt(6)
  v_mfma_f32_32x32x16_bf16 v[16:31], v[144:147], v[112:115], v[16:31]
  ds_read_b64_tr_b16 v[160:161], v10 offset:4096
  ds_read_b64_tr_b16 v[162:163], v10 offset:6144
  s_waitcnt lgkmcnt(6)
  v_mfma_f32_32x32x16_bf16 v[32:47], v[148:151], v[112:115], v[32:47]
  ds_read_b64_tr_b16 v[164:165], v11 offset:4096
  ds_read_b64_tr_b16 v[166:167], v11 offset:6144
  s_waitcnt lgkmcnt(6)
  v_mfma_f32_32x32x16_bf16 v[48:63], v[152:155], v[112:115], v[48:63]
  ds_read_b64_tr_b16 v[168:169], v12 offset:4096
  ds_read_b64_tr_b16 v[170:171], v12 offset:6144
  s_waitcnt lgkmcnt(6)
  v_mfma_f32_32x32x16_bf16 v[64:79], v[156:159], v[112:115], v[64:79]
  ds_read_b64_tr_b16 v[172:173], v13 offset:4096
  ds_read_b64_tr_b16 v[174:175], v13 offset:6144
  s_waitcnt lgkmcnt(6)
  v_mfma_f32_32x32x16_bf16 v[16:31], v[160:163], v[116:119], v[16:31]
  ds_read_b64_tr_b16 v[144:145], v10 offset:8192
  ds_read_b64_tr_b16 v[146:147], v10 offset:10240
  s_waitcnt lgkmcnt(6)
  v_mfma_f32_32x32x16_bf16 v[32:47], v[164:167], v[116:119], v[32:47]
  ds_read_b64_tr_b16 v[148:149], v11 offset:8192
  ds_read_b64_tr_b16 v[150:151], v11 offset:10240
  s_waitcnt lgkmcnt(6)
  v_mfma_f32_32x32x16_bf16 v[48:63], v[168:171], v[116:119], v[48:63]
  ds_read_b64_tr_b16 v[152:153], v12 offset:8192
  ds_read_b64_tr_b16 v[154:155], v12 offset:10240
  s_waitcnt lgkmcnt(6)
  v_mfma_f32_32x32x16_bf16 v[64:79], v[172:175], v[116:119], v[64:79]
  ds_read_b64_tr_b16 v[156:157], v13 offset:8192
  ds_read_b64_tr_b16 v[158:159], v13 offset:10240
  s_waitcnt lgkmcnt(6)
  v_mfma_f32_32x32x16_bf16 v[16:31], v[144:147], v[120:123], v[16:31]
  ds_read_b64_tr_b16 v[160:161], v10 offset:12288
  ds_read_b64_tr_b16 v[162:163], v10 offset:14336
  s_waitcnt lgkmcnt(6)
  v_mfma_f32_32x32x16_bf16 v[32:47], v[148:151], v[120:123], v[32:47]
  ds_read_b64_tr_b16 v[164:165], v11 offset:12288
  ds_read_b64_tr_b16 v[166:167], v11 offset:14336
  s_waitcnt lgkmcnt(6)
  v_mfma_f32_32x32x16_bf16 v[48:63], v[152:155], v[120:123], v[48:63]
  ds_read_b64_tr_b16 v[168:169], v12 offset:12288
  ds_read_b64_tr_b16 v[170:171], v12 offset:14336
  s_waitcnt lgkmcnt(6)
  v_mfma_f32_32x32x16_bf16 v[64:79], v[156:159], v[120:123], v[64:79]
  ds_read_b64_tr_b16 v[172:173], v13 offset:12288
  ds_read_b64_tr_b16 v[174:175], v13 offset:14336
  s_waitcnt vmcnt(0)
  ds_read_b128 v[128:131], v245
  ds_read_b128 v[132:135], v246
  ds_read_b128 v[136:139], v247
  ds_read_b128 v[140:143], v248
  s_waitcnt lgkmcnt(10)
  v_mfma_f32_32x32x16_bf16 v[16:31], v[160:163], v[124:127], v[16:31]
  ds_read_b64_tr_b16 v[144:145], v10 offset:16384
  ds_read_b64_tr_b16 v[146:147], v10 offset:18432
  s_waitcnt lgkmcnt(10)
  v_mfma_f32_32x32x16_bf16 v[32:47], v[164:167], v[124:127], v[32:47]
  ds_read_b64_tr_b16 v[148:149], v11 offset:16384
  ds_read_b64_tr_b16 v[150:151], v11 offset:18432
  s_waitcnt lgkmcnt(10)
  v_mfma_f32_32x32x16_bf16 v[48:63], v[168:171], v[124:127], v[48:63]
  ds_read_b64_tr_b16 v[152:153], v12 offset:16384
  ds_read_b64_tr_b16 v[154:155], v12 offset:18432
  s_waitcnt lgkmcnt(10)
  v_mfma_f32_32x32x16_bf16 v[64:79], v[172:175], v[124:127], v[64:79]
  ds_read_b64_tr_b16 v[156:157], v13 offset:16384
  ds_read_b64_tr_b16 v[158:159], v13 offset:18432
  s_waitcnt lgkmcnt(6)
  v_mfma_f32_32x32x16_bf16 v[16:31], v[144:147], v[128:131], v[16:31]
  ds_read_b64_tr_b16 v[160:161], v10 offset:20480
  ds_read_b64_tr_b16 v[162:163], v10 offset:22528
  s_waitcnt lgkmcnt(6)
  v_mfma_f32_32x32x16_bf16 v[32:47], v[148:151], v[128:131], v[32:47]
  ds_read_b64_tr_b16 v[164:165], v11 offset:20480
  ds_read_b64_tr_b16 v[166:167], v11 offset:22528
  s_waitcnt lgkmcnt(6)
  v_mfma_f32_32x32x16_bf16 v[48:63], v[152:155], v[128:131], v[48:63]
  ds_read_b64_tr_b16 v[168:169], v12 offset:20480
  ds_read_b64_tr_b16 v[170:171], v12 offset:22528
  s_waitcnt lgkmcnt(6)
  v_mfma_f32_32x32x16_bf16 v[64:79], v[156:159], v[128:131], v[64:79]
  ds_read_b64_tr_b16 v[172:173], v13 offset:20480
  ds_read_b64_tr_b16 v[174:175], v13 offset:22528
  s_waitcnt lgkmcnt(6)
  v_mfma_f32_32x32x16_bf16 v[16:31], v[160:163], v[132:135], v[16:31]
  ds_read_b64_tr_b16 v[144:145], v10 offset:24576
  ds_read_b64_tr_b16 v[146:147], v10 offset:26624
  s_waitcnt lgkmcnt(6)
  v_mfma_f32_32x32x16_bf16 v[32:47], v[164:167], v[132:135], v[32:47]
  ds_read_b64_tr_b16 v[148:149], v11 offset:24576
  ds_read_b64_tr_b16 v[150:151], v11 offset:26624
  s_waitcnt lgkmcnt(6)
  v_mfma_f32_32x32x16_bf16 v[48:63], v[168:171], v[132:135], v[48:63]
  ds_read_b64_tr_b16 v[152:153], v12 offset:24576
  ds_read_b64_tr_b16 v[154:155], v12 offset:26624
  s_waitcnt lgkmcnt(6)
  v_mfma_f32_32x32x16_bf16 v[64:79], v[172:175], v[132:135], v[64:79]
  ds_read_b64_tr_b16 v[156:157], v13 offset:24576
  ds_read_b64_tr_b16 v[158:159], v13 offset:26624
  s_waitcnt lgkmcnt(6)
  v_mfma_f32_32x32x16_bf16 v[16:31], v[144:147], v[136:139], v[16:31]
  ds_read_b64_tr_b16 v[160:161], v10 offset:28672
  ds_read_b64_tr_b16 v[162:163], v10 offset:30720
  s_waitcnt lgkmcnt(6)
  v_mfma_f32_32x32x16_bf16 v[32:47], v[148:151], v[136:139], v[32:47]
  ds_read_b64_tr_b16 v[164:165], v11 offset:28672
  ds_read_b64_tr_b16 v[166:167], v11 offset:30720
  s_waitcnt lgkmcnt(6)
  v_mfma_f32_32x32x16_bf16 v[48:63], v[152:155], v[136:139], v[48:63]
  ds_read_b64_tr_b16 v[168:169], v12 offset:28672
  ds_read_b64_tr_b16 v[170:171], v12 offset:30720
  s_waitcnt lgkmcnt(6)
  v_mfma_f32_32x32x16_bf16 v[64:79], v[156:159], v[136:139], v[64:79]
  ds_read_b64_tr_b16 v[172:173], v13 offset:28672
  ds_read_b64_tr_b16 v[174:175], v13 offset:30720
  s_waitcnt lgkmcnt(6)
  v_mfma_f32_32x32x16_bf16 v[16:31], v[160:163], v[140:143], v[16:31]
  s_waitcnt lgkmcnt(4)
  v_mfma_f32_32x32x16_bf16 v[32:47], v[164:167], v[140:143], v[32:47]
  s_waitcnt lgkmcnt(2)
  v_mfma_f32_32x32x16_bf16 v[48:63], v[168:171], v[140:143], v[48:63]
  s_waitcnt lgkmcnt(0)
  v_mfma_f32_32x32x16_bf16 v[64:79], v[172:175], v[140:143], v[64:79]
  s_add_u32 s39, s37, 32768
  s_cmp_eq_u32 s39, 131072
  s_cselect_b32 s39, 0, s39
  s_sub_u32 s29, s39, s37
  s_mov_b32 s37, s39
  s_mov_b32 s39, s29
  v_add_u32 v2, s39, v2
  v_add_u32 v3, s39, v3
  v_add_u32 v4, s39, v4
  v_add_u32 v5, s39, v5
  v_add_u32 v6, s39, v6
  v_add_u32 v7, s39, v7
  v_add_u32 v8, s39, v8
  v_add_u32 v9, s39, v9
  v_add_u32 v10, s39, v10
  v_add_u32 v11, s39, v11
  v_add_u32 v12, s39, v12
  v_add_u32 v13, s39, v13
  v_mul_f32 v16, s63, v16
  v_mul_f32 v17, s63, v17
  v_cvt_pk_bf16_f32 v80, v16, v17
  v_mul_f32 v18, s63, v18
  v_mul_f32 v19, s63, v19
  v_cvt_pk_bf16_f32 v81, v18, v19
  v_mul_f32 v20, s63, v20
  v_mul_f32 v21, s63, v21
  v_cvt_pk_bf16_f32 v82, v20, v21
  v_mul_f32 v22, s63, v22
  v_mul_f32 v23, s63, v23
  v_cvt_pk_bf16_f32 v83, v22, v23
  v_mul_f32 v24, s63, v24
  v_mul_f32 v25, s63, v25
  v_cvt_pk_bf16_f32 v84, v24, v25
  v_mul_f32 v26, s63, v26
  v_mul_f32 v27, s63, v27
  v_cvt_pk_bf16_f32 v85, v26, v27
  v_mul_f32 v28, s63, v28
  v_mul_f32 v29, s63, v29
  v_cvt_pk_bf16_f32 v86, v28, v29
  v_mul_f32 v30, s63, v30
  v_mul_f32 v31, s63, v31
  v_cvt_pk_bf16_f32 v87, v30, v31
  v_mul_f32 v32, s63, v32
  v_mul_f32 v33, s63, v33
  v_cvt_pk_bf16_f32 v88, v32, v33
  v_mul_f32 v34, s63, v34
  v_mul_f32 v35, s63, v35
  v_cvt_pk_bf16_f32 v89, v34, v35
  v_mul_f32 v36, s63, v36
  v_mul_f32 v37, s63, v37
  v_cvt_pk_bf16_f32 v90, v36, v37
  v_mul_f32 v38, s63, v38
  v_mul_f32 v39, s63, v39
  v_cvt_pk_bf16_f32 v91, v38, v39
  v_mul_f32 v40, s63, v40
  v_mul_f32 v41, s63, v41
  v_cvt_pk_bf16_f32 v92, v40, v41
  v_mul_f32 v42, s63, v42
  v_mul_f32 v43, s63, v43
  v_cvt_pk_bf16_f32 v93, v42, v43
  v_mul_f32 v44, s63, v44
  v_mul_f32 v45, s63, v45
  v_cvt_pk_bf16_f32 v94, v44, v45
  v_mul_f32 v46, s63, v46
  v_mul_f32 v47, s63, v47
  v_cvt_pk_bf16_f32 v95, v46, v47
  v_mul_f32 v48, s63, v48
  v_mul_f32 v49, s63, v49
  v_cvt_pk_bf16_f32 v96, v48, v49
  v_mul_f32 v50, s63, v50
  v_mul_f32 v51, s63, v51
  v_cvt_pk_bf16_f32 v97, v50, v51
  v_mul_f32 v52, s63, v52
  v_mul_f32 v53, s63, v53
  v_cvt_pk_bf16_f32 v98, v52, v53
  v_mul_f32 v54, s63, v54
  v_mul_f32 v55, s63, v55
  v_cvt_pk_bf16_f32 v99, v54, v55
  v_mul_f32 v56, s63, v56
  v_mul_f32 v57, s63, v57
  v_cvt_pk_bf16_f32 v100, v56, v57
  v_mul_f32 v58, s63, v58
  v_mul_f32 v59, s63, v59
  v_cvt_pk_bf16_f32 v101, v58, v59
  v_mul_f32 v60, s63, v60
  v_mul_f32 v61, s63, v61
  v_cvt_pk_bf16_f32 v102, v60, v61
  v_mul_f32 v62, s63, v62
  v_mul_f32 v63, s63, v63
  v_cvt_pk_bf16_f32 v103, v62, v63
  v_mul_f32 v64, s63, v64
  v_mul_f32 v65, s63, v65
  v_cvt_pk_bf16_f32 v104, v64, v65
  v_mul_f32 v66, s63, v66
  v_mul_f32 v67, s63, v67
  v_cvt_pk_bf16_f32 v105, v66, v67
  v_mul_f32 v68, s63, v68
  v_mul_f32 v69, s63, v69
  v_cvt_pk_bf16_f32 v106, v68, v69
  v_mul_f32 v70, s63, v70
  v_mul_f32 v71, s63, v71
  v_cvt_pk_bf16_f32 v107, v70, v71
  v_mul_f32 v72, s63, v72
  v_mul_f32 v73, s63, v73
  v_cvt_pk_bf16_f32 v108, v72, v73
  v_mul_f32 v74, s63, v74
  v_mul_f32 v75, s63, v75
  v_cvt_pk_bf16_f32 v109, v74, v75
  v_mul_f32 v76, s63, v76
  v_mul_f32 v77, s63, v77
  v_cvt_pk_bf16_f32 v110, v76, v77
  v_mul_f32 v78, s63, v78
  v_mul_f32 v79, s63, v79
  v_cvt_pk_bf16_f32 v111, v78, v79
  v_mov_b32 v16, 0
  v_mov_b32 v17, 0
  v_mov_b32 v18, 0
  v_mov_b32 v19, 0
  v_mov_b32 v20, 0
  v_mov_b32 v21, 0
  v_mov_b32 v22, 0
  v_mov_b32 v23, 0
  v_mov_b32 v24, 0
  v_mov_b32 v25, 0
  v_mov_b32 v26, 0
  v_mov_b32 v27, 0
  v_mov_b32 v28, 0
  v_mov_b32 v29, 0
  v_mov_b32 v30, 0
  v_mov_b32 v31, 0
  v_mov_b32 v32, 0
  v_mov_b32 v33, 0
  v_mov_b32 v34, 0
  v_mov_b32 v35, 0
  v_mov_b32 v36, 0
  v_mov_b32 v37, 0
  v_mov_b32 v38, 0
  v_mov_b32 v39, 0
  v_mov_b32 v40, 0
  v_mov_b32 v41, 0
  v_mov_b32 v42, 0
  v_mov_b32 v43, 0
  v_mov_b32 v44, 0
  v_mov_b32 v45, 0
  v_mov_b32 v46, 0
  v_mov_b32 v47, 0
  v_mov_b32 v48, 0
  v_mov_b32 v49, 0
  v_mov_b32 v50, 0
  v_mov_b32 v51, 0
  v_mov_b32 v52, 0
  v_mov_b32 v53, 0
  v_mov_b32 v54, 0
  v_mov_b32 v55, 0
  v_mov_b32 v56, 0
  v_mov_b32 v57, 0
  v_mov_b32 v58, 0
  v_mov_b32 v59, 0
  v_mov_b32 v60, 0
  v_mov_b32 v61, 0
  v_mov_b32 v62, 0
  v_mov_b32 v63, 0
  v_mov_b32 v64, 0
  v_mov_b32 v65, 0
  v_mov_b32 v66, 0
  v_mov_b32 v67, 0
  v_mov_b32 v68, 0
  v_mov_b32 v69, 0
  v_mov_b32 v70, 0
  v_mov_b32 v71, 0
  v_mov_b32 v72, 0
  v_mov_b32 v73, 0
  v_mov_b32 v74, 0
  v_mov_b32 v75, 0
  v_mov_b32 v76, 0
  v_mov_b32 v77, 0
  v_mov_b32 v78, 0
  v_mov_b32 v79, 0
  v_mov_b32 v14, 0
  v_mov_b32 v15, 0
  s_cmp_eq_u32 s65, 1
  s_cbranch_scc1 MODE1
  s_cmp_eq_u32 s65, 2
  s_cbranch_scc1 MODE2
  s_waitcnt lgkmcnt(0)
  s_nop 13
  s_barrier
  ds_read_b128 v[144:147], v2 offset:0
  ds_read_b128 v[148:151], v3 offset:0
  ds_read_b128 v[152:155], v4 offset:0
  ds_read_b128 v[156:159], v5 offset:0
  ds_read_b128 v[160:163], v6 offset:0
  ds_read_b128 v[164:167], v7 offset:0
  ds_read_b128 v[168:171], v8 offset:0
  ds_read_b128 v[172:175], v9 offset:0
  s_waitcnt lgkmcnt(7)
  v_mfma_f32_32x32x16_bf16 v[112:127], v[144:147], v[80:83], 0
  ds_read_b128 v[144:147], v2 offset:8192
  s_waitcnt lgkmcnt(7)
  v_mfma_f32_32x32x16_bf16 v[112:127], v[148:151], v[84:87], v[112:127]
  ds_read_b128 v[148:151], v3 offset:8192
  s_waitcnt lgkmcnt(7)
  v_mfma_f32_32x32x16_bf16 v[112:127], v[152:155], v[88:91], v[112:127]
  ds_read_b128 v[152:155], v4 offset:8192
  s_waitcnt lgkmcnt(7)
  v_mfma_f32_32x32x16_bf16 v[112:127], v[156:159], v[92:95], v[112:127]
  ds_read_b128 v[156:159], v5 offset:8192
  s_waitcnt lgkmcnt(7)
  v_mfma_f32_32x32x16_bf16 v[112:127], v[160:163], v[96:99], v[112:127]
  ds_read_b128 v[160:163], v6 offset:8192
  s_waitcnt lgkmcnt(7)
  v_mfma_f32_32x32x16_bf16 v[112:127], v[164:167], v[100:103], v[112:127]
  ds_read_b128 v[164:167], v7 offset:8192
  s_waitcnt lgkmcnt(7)
  v_mfma_f32_32x32x16_bf16 v[112:127], v[168:171], v[104:107], v[112:127]
  ds_read_b128 v[168:171], v8 offset:8192
  s_waitcnt lgkmcnt(7)
  v_mfma_f32_32x32x16_bf16 v[112:127], v[172:175], v[108:111], v[112:127]
  ds_read_b128 v[172:175], v9 offset:8192
  ds_read_b64_tr_b16 v[176:177], v10 offset:16384
  ds_read_b64_tr_b16 v[178:179], v10 offset:18432
  ds_read_b64_tr_b16 v[184:185], v11 offset:16384
  ds_read_b64_tr_b16 v[186:187], v11 offset:18432
  ds_read_b64_tr_b16 v[192:193], v12 offset:16384
  ds_read_b64_tr_b16 v[194:195], v12 offset:18432
  ds_read_b64_tr_b16 v[200:201], v13 offset:16384
  ds_read_b64_tr_b16 v[202:203], v13 offset:18432
  ds_read_b64_tr_b16 v[180:181], v10 offset:20480
  ds_read_b64_tr_b16 v[182:183], v10 offset:22528
  ds_read_b64_tr_b16 v[188:189], v11 offset:20480
  ds_read_b64_tr_b16 v[190:191], v11 offset:22528
  ds_read_b64_tr_b16 v[196:197], v12 offset:20480
  ds_read_b64_tr_b16 v[198:199], v12 offset:22528
  ds_read_b64_tr_b16 v[204:205], v13 offset:20480
  ds_read_b64_tr_b16 v[206:207], v13 offset:22528
  s_waitcnt lgkmcnt(15)
  v_mfma_f32_32x32x16_bf16 v[128:143], v[144:147], v[80:83], 0
  ds_read_b64_tr_b16 v[208:209], v10 offset:24576
  ds_read_b64_tr_b16 v[210:211], v10 offset:26624
  ds_read_b64_tr_b16 v[216:217], v11 offset:24576
  v_mfma_f32_32x32x16_bf16 v[128:143], v[148:151], v[84:87], v[128:143]
  ds_read_b64_tr_b16 v[218:219], v11 offset:26624
  ds_read_b64_tr_b16 v[224:225], v12 offset:24576
  ds_read_b64_tr_b16 v[226:227], v12 offset:26624
  v_exp_f32 v112, v112
  v_exp_f32 v113, v113
  v_exp_f32 v114, v114
  v_exp_f32 v115, v115
  v_add_f32 v14, v14, v112
  v_mfma_f32_32x32x16_bf16 v[128:143], v[152:155], v[88:91], v[128:143]
  ds_read_b64_tr_b16 v[232:233], v13 offset:24576
  ds_read_b64_tr_b16 v[234:235], v13 offset:26624
  ds_read_b64_tr_b16 v[212:213], v10 offset:28672
  v_add_f32 v15, v15, v113
  v_cvt_pk_bf16_f32 v112, v112, v113
  v_exp_f32 v116, v116
  v_exp_f32 v117, v117
  v_add_f32 v14, v14, v114
  v_add_f32 v15, v15, v115
  v_mfma_f32_32x32x16_bf16 v[128:143], v[156:159], v[92:95], v[128:143]
  ds_read_b64_tr_b16 v[214:215], v10 offset:30720
  ds_read_b64_tr_b16 v[220:221], v11 offset:28672
  ds_read_b64_tr_b16 v[222:223], v11 offset:30720
  v_cvt_pk_bf16_f32 v113, v114, v115
  v_exp_f32 v118, v118
  v_exp_f32 v119, v119
  v_add_f32 v14, v14, v116
  v_add_f32 v15, v15, v117
  v_cvt_pk_bf16_f32 v114, v116, v117
  v_mfma_f32_32x32x16_bf16 v[128:143], v[160:163], v[96:99], v[128:143]
  ds_read_b64_tr_b16 v[228:229], v12 offset:28672
  ds_read_b64_tr_b16 v[230:231], v12 offset:30720
  ds_read_b64_tr_b16 v[236:237], v13 offset:28672
  ds_read_b64_tr_b16 v[238:239], v13 offset:30720
  v_exp_f32 v120, v120
  v_exp_f32 v121, v121
  v_add_f32 v14, v14, v118
  v_add_f32 v15, v15, v119
  v_cvt_pk_bf16_f32 v115, v118, v119
  v_mfma_f32_32x32x16_bf16 v[128:143], v[164:167], v[100:103], v[128:143]
  v_exp_f32 v122, v122
  v_exp_f32 v123, v123
  v_add_f32 v14, v14, v120
  v_add_f32 v15, v15, v121
  v_cvt_pk_bf16_f32 v116, v120, v121
  v_exp_f32 v124, v124
  v_mfma_f32_32x32x16_bf16 v[128:143], v[168:171], v[104:107], v[128:143]
  v_exp_f32 v125, v125
  v_add_f32 v14, v14, v122
  v_add_f32 v15, v15, v123
  v_cvt_pk_bf16_f32 v117, v122, v123
  v_exp_f32 v126, v126
  v_exp_f32 v127, v127
  v_mfma_f32_32x32x16_bf16 v[128:143], v[172:175], v[108:111], v[128:143]
  v_add_f32 v14, v14, v124
  v_add_f32 v15, v15, v125
  v_cvt_pk_bf16_f32 v118, v124, v125
  v_add_f32 v14, v14, v126
  v_add_f32 v15, v15, v127
  v_cvt_pk_bf16_f32 v119, v126, v127
  s_add_u32 s39, s37, 32768
  s_cmp_eq_u32 s39, 131072
  s_cselect_b32 s39, 0, s39
  s_sub_u32 s29, s39, s37
  s_mov_b32 s37, s39
  s_mov_b32 s39, s29
  v_add_u32 v2, s39, v2
  v_add_u32 v3, s39, v3
  v_add_u32 v4, s39, v4
  v_add_u32 v5, s39, v5
  v_add_u32 v6, s39, v6
  v_add_u32 v7, s39, v7
  v_add_u32 v8, s39, v8
  v_add_u32 v9, s39, v9
  v_add_u32 v10, s39, v10
  v_add_u32 v11, s39, v11
  v_add_u32 v12, s39, v12
  v_add_u32 v13, s39, v13
  s_waitcnt lgkmcnt(0)
  s_mov_b32 s36, 15
  s_waitcnt lgkmcnt(0)
  s_nop 13
KV_LOOP:
  s_barrier
  v_mfma_f32_32x32x16_bf16 v[16:31], v[176:179], v[112:115], v[16:31]
  ds_read_b128 v[144:147], v2 offset:0
  v_exp_f32 v128, v128
  v_exp_f32 v129, v129
  v_mfma_f32_32x32x16_bf16 v[32:47], v[184:187], v[112:115], v[32:47]
  ds_read_b128 v[148:151], v3 offset:0
  v_exp_f32 v130, v130
  v_exp_f32 v131, v131
  v_add_f32 v14, v14, v128
  v_mfma_f32_32x32x16_bf16 v[48:63], v[192:195], v[112:115], v[48:63]
  ds_read_b128 v[152:155], v4 offset:0
  v_add_f32 v15, v15, v129
  v_cvt_pk_bf16_f32 v128, v128, v129
  v_mfma_f32_32x32x16_bf16 v[64:79], v[200:203], v[112:115], v[64:79]
  ds_read_b128 v[156:159], v5 offset:0
  v_exp_f32 v132, v132
  v_exp_f32 v133, v133
  v_add_f32 v14, v14, v130
  v_mfma_f32_32x32x16_bf16 v[16:31], v[180:183], v[116:119], v[16:31]
  ds_read_b128 v[160:163], v6 offset:0
  v_add_f32 v15, v15, v131
  v_cvt_pk_bf16_f32 v129, v130, v131
  v_mfma_f32_32x32x16_bf16 v[32:47], v[188:191], v[116:119], v[32:47]
  ds_read_b128 v[164:167], v7 offset:0
  v_exp_f32 v134, v134
  v_exp_f32 v135, v135
  v_add_f32 v14, v14, v132
  v_mfma_f32_32x32x16_bf16 v[48:63], v[196:199], v[116:119], v[48:63]
  ds_read_b128 v[168:171], v8 offset:0
  v_add_f32 v15, v15, v133
  v_cvt_pk_bf16_f32 v130, v132, v133
  v_mfma_f32_32x32x16_bf16 v[64:79], v[204:207], v[116:119], v[64:79]
  ds_read_b128 v[172:175], v9 offset:0
  v_exp_f32 v136, v136
  v_exp_f32 v137, v137
  v_add_f32 v14, v14, v134
  s_waitcnt lgkmcnt(7)
  v_mfma_f32_32x32x16_bf16 v[112:127], v[144:147], v[80:83], 0
  ds_read_b128 v[144:147], v2 offset:8192
  v_add_f32 v15, v15, v135
  v_cvt_pk_bf16_f32 v131, v134, v135
  s_waitcnt lgkmcnt(7)
  v_mfma_f32_32x32x16_bf16 v[112:127], v[148:151], v[84:87], v[112:127]
  ds_read_b128 v[148:151], v3 offset:8192
  v_exp_f32 v138, v138
  v_exp_f32 v139, v139
  v_add_f32 v14, v14, v136
  s_waitcnt lgkmcnt(7)
  v_mfma_f32_32x32x16_bf16 v[112:127], v[152:155], v[88:91], v[112:127]
  ds_read_b128 v[152:155], v4 offset:8192
  v_add_f32 v15, v15, v137
  v_cvt_pk_bf16_f32 v132, v136, v137
  s_waitcnt lgkmcnt(7)
  v_mfma_f32_32x32x16_bf16 v[112:127], v[156:159], v[92:95], v[112:127]
  ds_read_b128 v[156:159], v5 offset:8192
  v_exp_f32 v140, v140
  v_exp_f32 v141, v141
  v_add_f32 v14, v14, v138
  s_waitcnt lgkmcnt(7)
  v_mfma_f32_32x32x16_bf16 v[112:127], v[160:163], v[96:99], v[112:127]
  ds_read_b128 v[160:163], v6 offset:8192
  v_add_f32 v15, v15, v139
  v_cvt_pk_bf16_f32 v133, v138, v139
  s_waitcnt lgkmcnt(7)
  v_mfma_f32_32x32x16_bf16 v[112:127], v[164:167], v[100:103], v[112:127]
  ds_read_b128 v[164:167], v7 offset:8192
  v_exp_f32 v142, v142
  v_exp_f32 v143, v143
  v_add_f32 v14, v14, v140
  s_waitcnt lgkmcnt(7)
  v_mfma_f32_32x32x16_bf16 v[112:127], v[168:171], v[104:107], v[112:127]
  ds_read_b128 v[168:171], v8 offset:8192
  v_add_f32 v15, v15, v141
  v_cvt_pk_bf16_f32 v134, v140, v141
  s_waitcnt lgkmcnt(7)
  v_mfma_f32_32x32x16_bf16 v[112:127], v[172:175], v[108:111], v[112:127]
  ds_read_b128 v[172:175], v9 offset:8192
  v_add_f32 v14, v14, v142
  v_add_f32 v15, v15, v143
  v_cvt_pk_bf16_f32 v135, v142, v143
  v_mfma_f32_32x32x16_bf16 v[16:31], v[208:211], v[128:131], v[16:31]
  ds_read_b64_tr_b16 v[176:177], v10 offset:16384
  ds_read_b64_tr_b16 v[178:179], v10 offset:18432
  v_mfma_f32_32x32x16_bf16 v[32:47], v[216:219], v[128:131], v[32:47]
  ds_read_b64_tr_b16 v[184:185], v11 offset:16384
  ds_read_b64_tr_b16 v[186:187], v11 offset:18432
  v_mfma_f32_32x32x16_bf16 v[48:63], v[224:227], v[128:131], v[48:63]
  ds_read_b64_tr_b16 v[192:193], v12 offset:16384
  ds_read_b64_tr_b16 v[194:195], v12 offset:18432
  v_exp_f32 v112, v112
  v_exp_f32 v113, v113
  v_exp_f32 v114, v114
  v_mfma_f32_32x32x16_bf16 v[64:79], v[232:235], v[128:131], v[64:79]
  ds_read_b64_tr_b16 v[200:201], v13 offset:16384
  ds_read_b64_tr_b16 v[202:203], v13 offset:18432
  v_exp_f32 v115, v115
  v_add_f32 v14, v14, v112
  v_add_f32 v15, v15, v113
  v_mfma_f32_32x32x16_bf16 v[16:31], v[212:215], v[132:135], v[16:31]
  ds_read_b64_tr_b16 v[180:181], v10 offset:20480
  ds_read_b64_tr_b16 v[182:183], v10 offset:22528
  v_cvt_pk_bf16_f32 v112, v112, v113
  v_exp_f32 v116, v116
  v_exp_f32 v117, v117
  v_add_f32 v14, v14, v114
  v_mfma_f32_32x32x16_bf16 v[32:47], v[220:223], v[132:135], v[32:47]
  ds_read_b64_tr_b16 v[188:189], v11 offset:20480
  ds_read_b64_tr_b16 v[190:191], v11 offset:22528
  v_add_f32 v15, v15, v115
  v_cvt_pk_bf16_f32 v113, v114, v115
  v_exp_f32 v118, v118
  v_mfma_f32_32x32x16_bf16 v[48:63], v[228:231], v[132:135], v[48:63]
  ds_read_b64_tr_b16 v[196:197], v12 offset:20480
  ds_read_b64_tr_b16 v[198:199], v12 offset:22528
  v_exp_f32 v119, v119
  v_add_f32 v14, v14, v116
  v_add_f32 v15, v15, v117
  v_mfma_f32_32x32x16_bf16 v[64:79], v[236:239], v[132:135], v[64:79]
  ds_read_b64_tr_b16 v[204:205], v13 offset:20480
  ds_read_b64_tr_b16 v[206:207], v13 offset:22528
  v_cvt_pk_bf16_f32 v114, v116, v117
  v_exp_f32 v120, v120
  v_exp_f32 v121, v121
  v_add_f32 v14, v14, v118
  s_waitcnt lgkmcnt(15)
  v_mfma_f32_32x32x16_bf16 v[128:143], v[144:147], v[80:83], 0
  ds_read_b64_tr_b16 v[208:209], v10 offset:24576
  ds_read_b64_tr_b16 v[210:211], v10 offset:26624
  ds_read_b64_tr_b16 v[216:217], v11 offset:24576
  v_add_f32 v15, v15, v119
  v_cvt_pk_bf16_f32 v115, v118, v119
  v_mfma_f32_32x32x16_bf16 v[128:143], v[148:151], v[84:87], v[128:143]
  ds_read_b64_tr_b16 v[218:219], v11 offset:26624
  ds_read_b64_tr_b16 v[224:225], v12 offset:24576
  ds_read_b64_tr_b16 v[226:227], v12 offset:26624
  v_exp_f32 v122, v122
  v_exp_f32 v123, v123
  v_add_f32 v14, v14, v120
  v_mfma_f32_32x32x16_bf16 v[128:143], v[152:155], v[88:91], v[128:143]
  ds_read_b64_tr_b16 v[232:233], v13 offset:24576
  ds_read_b64_tr_b16 v[234:235], v13 offset:26624
  ds_read_b64_tr_b16 v[212:213], v10 offset:28672
  v_add_f32 v15, v15, v121
  v_cvt_pk_bf16_f32 v116, v120, v121
  v_mfma_f32_32x32x16_bf16 v[128:143], v[156:159], v[92:95], v[128:143]
  ds_read_b64_tr_b16 v[214:215], v10 offset:30720
  ds_read_b64_tr_b16 v[220:221], v11 offset:28672
  ds_read_b64_tr_b16 v[222:223], v11 offset:30720
  v_exp_f32 v124, v124
  v_exp_f32 v125, v125
  v_add_f32 v14, v14, v122
  v_mfma_f32_32x32x16_bf16 v[128:143], v[160:163], v[96:99], v[128:143]
  ds_read_b64_tr_b16 v[228:229], v12 offset:28672
  ds_read_b64_tr_b16 v[230:231], v12 offset:30720
  ds_read_b64_tr_b16 v[236:237], v13 offset:28672
  ds_read_b64_tr_b16 v[238:239], v13 offset:30720
  v_add_f32 v15, v15, v123
  v_cvt_pk_bf16_f32 v117, v122, v123
  v_mfma_f32_32x32x16_bf16 v[128:143], v[164:167], v[100:103], v[128:143]
  v_exp_f32 v126, v126
  v_exp_f32 v127, v127
  v_add_f32 v14, v14, v124
  v_mfma_f32_32x32x16_bf16 v[128:143], v[168:171], v[104:107], v[128:143]
  v_add_f32 v15, v15, v125
  v_cvt_pk_bf16_f32 v118, v124, v125
  v_mfma_f32_32x32x16_bf16 v[128:143], v[172:175], v[108:111], v[128:143]
  v_add_f32 v14, v14, v126
  v_add_f32 v15, v15, v127
  v_cvt_pk_bf16_f32 v119, v126, v127
  s_add_u32 s39, s37, 32768
  s_cmp_eq_u32 s39, 131072
  s_cselect_b32 s39, 0, s39
  s_sub_u32 s29, s39, s37
  s_mov_b32 s37, s39
  s_mov_b32 s39, s29
  v_add_u32 v2, s39, v2
  v_add_u32 v3, s39, v3
  v_add_u32 v4, s39, v4
  v_add_u32 v5, s39, v5
  v_add_u32 v6, s39, v6
  v_add_u32 v7, s39, v7
  v_add_u32 v8, s39, v8
  v_add_u32 v9, s39, v9
  v_add_u32 v10, s39, v10
  v_add_u32 v11, s39, v11
  v_add_u32 v12, s39, v12
  v_add_u32 v13, s39, v13
  s_waitcnt lgkmcnt(0)
  s_sub_u32 s36, s36, 1
  s_cmp_lg_u32 s36, 0
  s_cbranch_scc1 KV_LOOP
  v_mfma_f32_32x32x16_bf16 v[16:31], v[176:179], v[112:115], v[16:31]
  v_exp_f32 v128, v128
  v_exp_f32 v129, v129
  v_exp_f32 v130, v130
  v_exp_f32 v131, v131
  v_add_f32 v14, v14, v128
  v_mfma_f32_32x32x16_bf16 v[32:47], v[184:187], v[112:115], v[32:47]
  v_add_f32 v15, v15, v129
  v_cvt_pk_bf16_f32 v128, v128, v129
  v_exp_f32 v132, v132
  v_exp_f32 v133, v133
  v_add_f32 v14, v14, v130
  v_mfma_f32_32x32x16_bf16 v[48:63], v[192:195], v[112:115], v[48:63]
  v_add_f32 v15, v15, v131
  v_cvt_pk_bf16_f32 v129, v130, v131
  v_exp_f32 v134, v134
  v_exp_f32 v135, v135
  v_add_f32 v14, v14, v132
  v_mfma_f32_32x32x16_bf16 v[64:79], v[200:203], v[112:115], v[64:79]
  v_add_f32 v15, v15, v133
  v_cvt_pk_bf16_f32 v130, v132, v133
  v_exp_f32 v136, v136
  v_exp_f32 v137, v137
  v_add_f32 v14, v14, v134
  v_mfma_f32_32x32x16_bf16 v[16:31], v[180:183], v[116:119], v[16:31]
  v_add_f32 v15, v15, v135
  v_cvt_pk_bf16_f32 v131, v134, v135
  v_exp_f32 v138, v138
  v_exp_f32 v139, v139
  v_add_f32 v14, v14, v136
  v_mfma_f32_32x32x16_bf16 v[32:47], v[188:191], v[116:119], v[32:47]
  v_add_f32 v15, v15, v137
  v_cvt_pk_bf16_f32 v132, v136, v137
  v_exp_f32 v140, v140
  v_exp_f32 v141, v141
  v_add_f32 v14, v14, v138
  v_mfma_f32_32x32x16_bf16 v[48:63], v[196:199], v[116:119], v[48:63]
  v_add_f32 v15, v15, v139
  v_cvt_pk_bf16_f32 v133, v138, v139
  v_exp_f32 v142, v142
  v_exp_f32 v143, v143
  v_add_f32 v14, v14, v140
  v_mfma_f32_32x32x16_bf16 v[64:79], v[204:207], v[116:119], v[64:79]
  v_add_f32 v15, v15, v141
  v_cvt_pk_bf16_f32 v134, v140, v141
  v_add_f32 v14, v14, v142
  v_add_f32 v15, v15, v143
  v_cvt_pk_bf16_f32 v135, v142, v143
  s_xor_b32 s34, s7, 1
  s_cmp_eq_u32 s34, 0
  s_cselect_b32 s20, s44, s52
  s_cselect_b32 s21, s45, s53
  s_mul_i32 s28, s5, 229376
  s_add_u32 s20, s20, s28
  s_addc_u32 s21, s21, 0
  s_add_u32 m0, s66, 0
  s_mov_b32 s31, 0
  buffer_load_dwordx4 v240, s[20:23], s31 offen lds
  s_add_u32 m0, s66, 1024
  s_mov_b32 s31, 8192
  buffer_load_dwordx4 v244, s[20:23], s31 offen lds
  s_add_u32 m0, s66, 2048
  s_mov_b32 s31, 16384
  buffer_load_dwordx4 v240, s[20:23], s31 offen lds
  s_add_u32 m0, s66, 3072
  s_mov_b32 s31, 24576
  buffer_load_dwordx4 v244, s[20:23], s31 offen lds
  v_mfma_f32_32x32x16_bf16 v[16:31], v[208:211], v[128:131], v[16:31]
  v_mfma_f32_32x32x16_bf16 v[32:47], v[216:219], v[128:131], v[32:47]
  v_mfma_f32_32x32x16_bf16 v[48:63], v[224:227], v[128:131], v[48:63]
  v_mfma_f32_32x32x16_bf16 v[64:79], v[232:235], v[128:131], v[64:79]
  v_mfma_f32_32x32x16_bf16 v[16:31], v[212:215], v[132:135], v[16:31]
  v_mfma_f32_32x32x16_bf16 v[32:47], v[220:223], v[132:135], v[32:47]
  v_mfma_f32_32x32x16_bf16 v[48:63], v[228:231], v[132:135], v[48:63]
  v_mfma_f32_32x32x16_bf16 v[64:79], v[236:239], v[132:135], v[64:79]
  s_waitcnt lgkmcnt(0)
  s_nop 13
  v_add_f32 v14, v14, v15
  v_mov_b32 v242, v14
  s_nop 1
  v_permlane32_swap_b32 v14, v242
  v_add_f32 v14, v14, v242
  v_cmp_le_f32 vcc, 0x30800000, v14
  s_nop 4
  s_mov_b64 s[34:35], vcc
  v_cmp_ge_f32 vcc, 0x4e800000, v14
  s_nop 4
  s_and_b64 vcc, vcc, s[34:35]
  s_cmp_eq_u64 vcc, -1
  s_cselect_b32 s33, 0, 1
  s_lshl_b32 s33, s33, s7
  s_or_b32 s40, s40, s33
  v_rcp_f32 v243, v14
  s_nop 0
  v_mul_f32 v16, v243, v16
  v_mul_f32 v17, v243, v17
  v_mul_f32 v18, v243, v18
  v_mul_f32 v19, v243, v19
  v_mul_f32 v20, v243, v20
  v_mul_f32 v21, v243, v21
  v_mul_f32 v22, v243, v22
  v_mul_f32 v23, v243, v23
  v_cvt_pk_bf16_f32 v144, v16, v17
  v_cvt_pk_bf16_f32 v145, v18, v19
  v_cvt_pk_bf16_f32 v146, v20, v21
  v_cvt_pk_bf16_f32 v147, v22, v23
  buffer_store_dwordx4 v[144:147], v241, s[24:27], 0 offen offset:0
  v_mul_f32 v24, v243, v24
  v_mul_f32 v25, v243, v25
  v_mul_f32 v26, v243, v26
  v_mul_f32 v27, v243, v27
  v_mul_f32 v28, v243, v28
  v_mul_f32 v29, v243, v29
  v_mul_f32 v30, v243, v30
  v_mul_f32 v31, v243, v31
  v_cvt_pk_bf16_f32 v148, v24, v25
  v_cvt_pk_bf16_f32 v149, v26, v27
  v_cvt_pk_bf16_f32 v150, v28, v29
  v_cvt_pk_bf16_f32 v151, v30, v31
  buffer_store_dwordx4 v[148:151], v241, s[24:27], 0 offen offset:1024
  v_mul_f32 v32, v243, v32
  v_mul_f32 v33, v243, v33
  v_mul_f32 v34, v243, v34
  v_mul_f32 v35, v243, v35
  v_mul_f32 v36, v243, v36
  v_mul_f32 v37, v243, v37
  v_mul_f32 v38, v243, v38
  v_mul_f32 v39, v243, v39
  v_cvt_pk_bf16_f32 v152, v32, v33
  v_cvt_pk_bf16_f32 v153, v34, v35
  v_cvt_pk_bf16_f32 v154, v36, v37
  v_cvt_pk_bf16_f32 v155, v38, v39
  buffer_store_dwordx4 v[152:155], v241, s[24:27], 0 offen offset:2048
  v_mul_f32 v40, v243, v40
  v_mul_f32 v41, v243, v41
  v_mul_f32 v42, v243, v42
  v_mul_f32 v43, v243, v43
  v_mul_f32 v44, v243, v44
  v_mul_f32 v45, v243, v45
  v_mul_f32 v46, v243, v46
  v_mul_f32 v47, v243, v47
  v_cvt_pk_bf16_f32 v156, v40, v41
  v_cvt_pk_bf16_f32 v157, v42, v43
  v_cvt_pk_bf16_f32 v158, v44, v45
  v_cvt_pk_bf16_f32 v159, v46, v47
  buffer_store_dwordx4 v[156:159], v241, s[24:27], 0 offen offset:3072
  v_mul_f32 v48, v243, v48
  v_mul_f32 v49, v243, v49
  v_mul_f32 v50, v243, v50
  v_mul_f32 v51, v243, v51
  v_mul_f32 v52, v243, v52
  v_mul_f32 v53, v243, v53
  v_mul_f32 v54, v243, v54
  v_mul_f32 v55, v243, v55
  v_cvt_pk_bf16_f32 v160, v48, v49
  v_cvt_pk_bf16_f32 v161, v50, v51
  v_cvt_pk_bf16_f32 v162, v52, v53
  v_cvt_pk_bf16_f32 v163, v54, v55
  buffer_store_dwordx4 v[160:163], v241, s[24:27], s64 offen offset:0
  v_mul_f32 v56, v243, v56
  v_mul_f32 v57, v243, v57
  v_mul_f32 v58, v243, v58
  v_mul_f32 v59, v243, v59
  v_mul_f32 v60, v243, v60
  v_mul_f32 v61, v243, v61
  v_mul_f32 v62, v243, v62
  v_mul_f32 v63, v243, v63
  v_cvt_pk_bf16_f32 v164, v56, v57
  v_cvt_pk_bf16_f32 v165, v58, v59
  v_cvt_pk_bf16_f32 v166, v60, v61
  v_cvt_pk_bf16_f32 v167, v62, v63
  buffer_store_dwordx4 v[164:167], v241, s[24:27], s64 offen offset:1024
  v_mul_f32 v64, v243, v64
  v_mul_f32 v65, v243, v65
  v_mul_f32 v66, v243, v66
  v_mul_f32 v67, v243, v67
  v_mul_f32 v68, v243, v68
  v_mul_f32 v69, v243, v69
  v_mul_f32 v70, v243, v70
  v_mul_f32 v71, v243, v71
  v_cvt_pk_bf16_f32 v168, v64, v65
  v_cvt_pk_bf16_f32 v169, v66, v67
  v_cvt_pk_bf16_f32 v170, v68, v69
  v_cvt_pk_bf16_f32 v171, v70, v71
  buffer_store_dwordx4 v[168:171], v241, s[24:27], s64 offen offset:2048
  v_mul_f32 v72, v243, v72
  v_mul_f32 v73, v243, v73
  v_mul_f32 v74, v243, v74
  v_mul_f32 v75, v243, v75
  v_mul_f32 v76, v243, v76
  v_mul_f32 v77, v243, v77
  v_mul_f32 v78, v243, v78
  v_mul_f32 v79, v243, v79
  v_cvt_pk_bf16_f32 v172, v72, v73
  v_cvt_pk_bf16_f32 v173, v74, v75
  v_cvt_pk_bf16_f32 v174, v76, v77
  v_cvt_pk_bf16_f32 v175, v78, v79
  buffer_store_dwordx4 v[172:175], v241, s[24:27], s64 offen offset:3072
  s_branch ITEM_END
MODE1:
  s_waitcnt lgkmcnt(0)
  s_nop 13
  v_mov_b32 v1, 0xff800000
  s_mov_b32 s36, 16
  s_waitcnt lgkmcnt(0)
  s_nop 13
KV_SLOW1:
  s_barrier
  ds_read_b128 v[144:147], v2 offset:0
  ds_read_b128 v[148:151], v3 offset:0
  ds_read_b128 v[152:155], v4 offset:0
  ds_read_b128 v[156:159], v5 offset:0
  ds_read_b128 v[160:163], v6 offset:0
  ds_read_b128 v[164:167], v7 offset:0
  ds_read_b128 v[168:171], v8 offset:0
  ds_read_b128 v[172:175], v9 offset:0
  s_waitcnt lgkmcnt(7)
  v_mfma_f32_32x32x16_bf16 v[112:127], v[144:147], v[80:83], 0
  s_waitcnt lgkmcnt(6)
  v_mfma_f32_32x32x16_bf16 v[112:127], v[148:151], v[84:87], v[112:127]
  s_waitcnt lgkmcnt(5)
  v_mfma_f32_32x32x16_bf16 v[112:127], v[152:155], v[88:91], v[112:127]
  s_waitcnt lgkmcnt(4)
  v_mfma_f32_32x32x16_bf16 v[112:127], v[156:159], v[92:95], v[112:127]
  s_waitcnt lgkmcnt(3)
  v_mfma_f32_32x32x16_bf16 v[112:127], v[160:163], v[96:99], v[112:127]
  s_waitcnt lgkmcnt(2)
  v_mfma_f32_32x32x16_bf16 v[112:127], v[164:167], v[100:103], v[112:127]
  s_waitcnt lgkmcnt(1)
  v_mfma_f32_32x32x16_bf16 v[112:127], v[168:171], v[104:107], v[112:127]
  s_waitcnt lgkmcnt(0)
  v_mfma_f32_32x32x16_bf16 v[112:127], v[172:175], v[108:111], v[112:127]
  s_nop 11
  v_max3_f32 v1, v1, v112, v113
  v_max3_f32 v1, v1, v114, v115
  v_max3_f32 v1, v1, v116, v117
  v_max3_f32 v1, v1, v118, v119
  v_max3_f32 v1, v1, v120, v121
  v_max3_f32 v1, v1, v122, v123
  v_max3_f32 v1, v1, v124, v125
  v_max3_f32 v1, v1, v126, v127
  ds_read_b128 v[144:147], v2 offset:8192
  ds_read_b128 v[148:151], v3 offset:8192
  ds_read_b128 v[152:155], v4 offset:8192
  ds_read_b128 v[156:159], v5 offset:8192
  ds_read_b128 v[160:163], v6 offset:8192
  ds_read_b128 v[164:167], v7 offset:8192
  ds_read_b128 v[168:171], v8 offset:8192
  ds_read_b128 v[172:175], v9 offset:8192
  s_waitcnt lgkmcnt(7)
  v_mfma_f32_32x32x16_bf16 v[128:143], v[144:147], v[80:83], 0
  s_waitcnt lgkmcnt(6)
  v_mfma_f32_32x32x16_bf16 v[128:143], v[148:151], v[84:87], v[128:143]
  s_waitcnt lgkmcnt(5)
  v_mfma_f32_32x32x16_bf16 v[128:143], v[152:155], v[88:91], v[128:143]
  s_waitcnt lgkmcnt(4)
  v_mfma_f32_32x32x16_bf16 v[128:143], v[156:159], v[92:95], v[128:143]
  s_waitcnt lgkmcnt(3)
  v_mfma_f32_32x32x16_bf16 v[128:143], v[160:163], v[96:99], v[128:143]
  s_waitcnt lgkmcnt(2)
  v_mfma_f32_32x32x16_bf16 v[128:143], v[164:167], v[100:103], v[128:143]
  s_waitcnt lgkmcnt(1)
  v_mfma_f32_32x32x16_bf16 v[128:143], v[168:171], v[104:107], v[128:143]
  s_waitcnt lgkmcnt(0)
  v_mfma_f32_32x32x16_bf16 v[128:143], v[172:175], v[108:111], v[128:143]
  s_nop 11
  v_max3_f32 v1, v1, v128, v129
  v_max3_f32 v1, v1, v130, v131
  v_max3_f32 v1, v1, v132, v133
  v_max3_f32 v1, v1, v134, v135
  v_max3_f32 v1, v1, v136, v137
  v_max3_f32 v1, v1, v138, v139
  v_max3_f32 v1, v1, v140, v141
  v_max3_f32 v1, v1, v142, v143
  s_waitcnt lgkmcnt(0)
  s_add_u32 s39, s37, 32768
  s_cmp_eq_u32 s39, 131072
  s_cselect_b32 s39, 0, s39
  s_sub_u32 s29, s39, s37
  s_mov_b32 s37, s39
  s_mov_b32 s39, s29
  v_add_u32 v2, s39, v2
  v_add_u32 v3, s39, v3
  v_add_u32 v4, s39, v4
  v_add_u32 v5, s39, v5
  v_add_u32 v6, s39, v6
  v_add_u32 v7, s39, v7
  v_add_u32 v8, s39, v8
  v_add_u32 v9, s39, v9
  v_add_u32 v10, s39, v10
  v_add_u32 v11, s39, v11
  v_add_u32 v12, s39, v12
  v_add_u32 v13, s39, v13
  s_sub_u32 s36, s36, 1
  s_cmp_lg_u32 s36, 0
  s_cbranch_scc1 KV_SLOW1
  s_waitcnt lgkmcnt(0)
  s_nop 13
  v_mov_b32 v242, v1
  s_nop 1
  v_permlane32_swap_b32 v1, v242
  v_max_f32 v1, v1, v242
  s_branch ITEM_END
MODE2:
  s_waitcnt lgkmcnt(0)
  s_nop 13
  s_mov_b32 s36, 16
  s_waitcnt lgkmcnt(0)
  s_nop 13
KV_SLOW2:
  s_barrier
  ds_read_b128 v[144:147], v2 offset:0
  ds_read_b128 v[148:151], v3 offset:0
  ds_read_b128 v[152:155], v4 offset:0
  ds_read_b128 v[156:159], v5 offset:0
  ds_read_b128 v[160:163], v6 offset:0
  ds_read_b128 v[164:167], v7 offset:0
  ds_read_b128 v[168:171], v8 offset:0
  ds_read_b128 v[172:175], v9 offset:0
  s_waitcnt lgkmcnt(7)
  v_mfma_f32_32x32x16_bf16 v[112:127], v[144:147], v[80:83], 0
  s_waitcnt lgkmcnt(6)
  v_mfma_f32_32x32x16_bf16 v[112:127], v[148:151], v[84:87], v[112:127]
  s_waitcnt lgkmcnt(5)
  v_mfma_f32_32x32x16_bf16 v[112:127], v[152:155], v[88:91], v[112:127]
  s_waitcnt lgkmcnt(4)
  v_mfma_f32_32x32x16_bf16 v[112:127], v[156:159], v[92:95], v[112:127]
  s_waitcnt lgkmcnt(3)
  v_mfma_f32_32x32x16_bf16 v[112:127], v[160:163], v[96:99], v[112:127]
  s_waitcnt lgkmcnt(2)
  v_mfma_f32_32x32x16_bf16 v[112:127], v[164:167], v[100:103], v[112:127]
  s_waitcnt lgkmcnt(1)
  v_mfma_f32_32x32x16_bf16 v[112:127], v[168:171], v[104:107], v[112:127]
  s_waitcnt lgkmcnt(0)
  v_mfma_f32_32x32x16_bf16 v[112:127], v[172:175], v[108:111], v[112:127]
  s_nop 11
  v_sub_f32 v112, v112, v1
  v_sub_f32 v113, v113, v1
  v_exp_f32 v112, v112
  v_exp_f32 v113, v113
  v_sub_f32 v114, v114, v1
  v_sub_f32 v115, v115, v1
  v_exp_f32 v114, v114
  v_exp_f32 v115, v115
  v_add_f32 v14, v14, v112
  v_add_f32 v15, v15, v113
  v_cvt_pk_bf16_f32 v112, v112, v113
  v_sub_f32 v116, v116, v1
  v_sub_f32 v117, v117, v1
  v_exp_f32 v116, v116
  v_exp_f32 v117, v117
  v_add_f32 v14, v14, v114
  v_add_f32 v15, v15, v115
  v_cvt_pk_bf16_f32 v113, v114, v115
  v_sub_f32 v118, v118, v1
  v_sub_f32 v119, v119, v1
  v_exp_f32 v118, v118
  v_exp_f32 v119, v119
  v_add_f32 v14, v14, v116
  v_add_f32 v15, v15, v117
  v_cvt_pk_bf16_f32 v114, v116, v117
  v_sub_f32 v120, v120, v1
  v_sub_f32 v121, v121, v1
  v_exp_f32 v120, v120
  v_exp_f32 v121, v121
  v_add_f32 v14, v14, v118
  v_add_f32 v15, v15, v119
  v_cvt_pk_bf16_f32 v115, v118, v119
  v_sub_f32 v122, v122, v1
  v_sub_f32 v123, v123, v1
  v_exp_f32 v122, v122
  v_exp_f32 v123, v123
  v_add_f32 v14, v14, v120
  v_add_f32 v15, v15, v121
  v_cvt_pk_bf16_f32 v116, v120, v121
  v_sub_f32 v124, v124, v1
  v_sub_f32 v125, v125, v1
  v_exp_f32 v124, v124
  v_exp_f32 v125, v125
  v_add_f32 v14, v14, v122
  v_add_f32 v15, v15, v123
  v_cvt_pk_bf16_f32 v117, v122, v123
  v_sub_f32 v126, v126, v1
  v_sub_f32 v127, v127, v1
  v_exp_f32 v126, v126
  v_exp_f32 v127, v127
  v_add_f32 v14, v14, v124
  v_add_f32 v15, v15, v125
  v_cvt_pk_bf16_f32 v118, v124, v125
  v_add_f32 v14, v14, v126
  v_add_f32 v15, v15, v127
  v_cvt_pk_bf16_f32 v119, v126, v127
  ds_read_b64_tr_b16 v[176:177], v10 offset:16384
  ds_read_b64_tr_b16 v[178:179], v10 offset:18432
  ds_read_b64_tr_b16 v[184:185], v11 offset:16384
  ds_read_b64_tr_b16 v[186:187], v11 offset:18432
  ds_read_b64_tr_b16 v[192:193], v12 offset:16384
  ds_read_b64_tr_b16 v[194:195], v12 offset:18432
  ds_read_b64_tr_b16 v[200:201], v13 offset:16384
  ds_read_b64_tr_b16 v[202:203], v13 offset:18432
  ds_read_b64_tr_b16 v[180:181], v10 offset:20480
  ds_read_b64_tr_b16 v[182:183], v10 offset:22528
  ds_read_b64_tr_b16 v[188:189], v11 offset:20480
  ds_read_b64_tr_b16 v[190:191], v11 offset:22528
  ds_read_b64_tr_b16 v[196:197], v12 offset:20480
  ds_read_b64_tr_b16 v[198:199], v12 offset:22528
  ds_read_b64_tr_b16 v[204:205], v13 offset:20480
  ds_read_b64_tr_b16 v[206:207], v13 offset:22528
  s_waitcnt lgkmcnt(14)
  v_mfma_f32_32x32x16_bf16 v[16:31], v[176:179], v[112:115], v[16:31]
  s_waitcnt lgkmcnt(12)
  v_mfma_f32_32x32x16_bf16 v[32:47], v[184:187], v[112:115], v[32:47]
  s_waitcnt lgkmcnt(10)
  v_mfma_f32_32x32x16_bf16 v[48:63], v[192:195], v[112:115], v[48:63]
  s_waitcnt lgkmcnt(8)
  v_mfma_f32_32x32x16_bf16 v[64:79], v[200:203], v[112:115], v[64:79]
  s_waitcnt lgkmcnt(6)
  v_mfma_f32_32x32x16_bf16 v[16:31], v[180:183], v[116:119], v[16:31]
  s_waitcnt lgkmcnt(4)
  v_mfma_f32_32x32x16_bf16 v[32:47], v[188:191], v[116:119], v[32:47]
  s_waitcnt lgkmcnt(2)
  v_mfma_f32_32x32x16_bf16 v[48:63], v[196:199], v[116:119], v[48:63]
  s_waitcnt lgkmcnt(0)
  v_mfma_f32_32x32x16_bf16 v[64:79], v[204:207], v[116:119], v[64:79]
  ds_read_b128 v[144:147], v2 offset:8192
  ds_read_b128 v[148:151], v3 offset:8192
  ds_read_b128 v[152:155], v4 offset:8192
  ds_read_b128 v[156:159], v5 offset:8192
  ds_read_b128 v[160:163], v6 offset:8192
  ds_read_b128 v[164:167], v7 offset:8192
  ds_read_b128 v[168:171], v8 offset:8192
  ds_read_b128 v[172:175], v9 offset:8192
  s_waitcnt lgkmcnt(7)
  v_mfma_f32_32x32x16_bf16 v[128:143], v[144:147], v[80:83], 0
  s_waitcnt lgkmcnt(6)
  v_mfma_f32_32x32x16_bf16 v[128:143], v[148:151], v[84:87], v[128:143]
  s_waitcnt lgkmcnt(5)
  v_mfma_f32_32x32x16_bf16 v[128:143], v[152:155], v[88:91], v[128:143]
  s_waitcnt lgkmcnt(4)
  v_mfma_f32_32x32x16_bf16 v[128:143], v[156:159], v[92:95], v[128:143]
  s_waitcnt lgkmcnt(3)
  v_mfma_f32_32x32x16_bf16 v[128:143], v[160:163], v[96:99], v[128:143]
  s_waitcnt lgkmcnt(2)
  v_mfma_f32_32x32x16_bf16 v[128:143], v[164:167], v[100:103], v[128:143]
  s_waitcnt lgkmcnt(1)
  v_mfma_f32_32x32x16_bf16 v[128:143], v[168:171], v[104:107], v[128:143]
  s_waitcnt lgkmcnt(0)
  v_mfma_f32_32x32x16_bf16 v[128:143], v[172:175], v[108:111], v[128:143]
  s_nop 11
  v_sub_f32 v128, v128, v1
  v_sub_f32 v129, v129, v1
  v_exp_f32 v128, v128
  v_exp_f32 v129, v129
  v_sub_f32 v130, v130, v1
  v_sub_f32 v131, v131, v1
  v_exp_f32 v130, v130
  v_exp_f32 v131, v131
  v_add_f32 v14, v14, v128
  v_add_f32 v15, v15, v129
  v_cvt_pk_bf16_f32 v128, v128, v129
  v_sub_f32 v132, v132, v1
  v_sub_f32 v133, v133, v1
  v_exp_f32 v132, v132
  v_exp_f32 v133, v133
  v_add_f32 v14, v14, v130
  v_add_f32 v15, v15, v131
  v_cvt_pk_bf16_f32 v129, v130, v131
  v_sub_f32 v134, v134, v1
  v_sub_f32 v135, v135, v1
  v_exp_f32 v134, v134
  v_exp_f32 v135, v135
  v_add_f32 v14, v14, v132
  v_add_f32 v15, v15, v133
  v_cvt_pk_bf16_f32 v130, v132, v133
  v_sub_f32 v136, v136, v1
  v_sub_f32 v137, v137, v1
  v_exp_f32 v136, v136
  v_exp_f32 v137, v137
  v_add_f32 v14, v14, v134
  v_add_f32 v15, v15, v135
  v_cvt_pk_bf16_f32 v131, v134, v135
  v_sub_f32 v138, v138, v1
  v_sub_f32 v139, v139, v1
  v_exp_f32 v138, v138
  v_exp_f32 v139, v139
  v_add_f32 v14, v14, v136
  v_add_f32 v15, v15, v137
  v_cvt_pk_bf16_f32 v132, v136, v137
  v_sub_f32 v140, v140, v1
  v_sub_f32 v141, v141, v1
  v_exp_f32 v140, v140
  v_exp_f32 v141, v141
  v_add_f32 v14, v14, v138
  v_add_f32 v15, v15, v139
  v_cvt_pk_bf16_f32 v133, v138, v139
  v_sub_f32 v142, v142, v1
  v_sub_f32 v143, v143, v1
  v_exp_f32 v142, v142
  v_exp_f32 v143, v143
  v_add_f32 v14, v14, v140
  v_add_f32 v15, v15, v141
  v_cvt_pk_bf16_f32 v134, v140, v141
  v_add_f32 v14, v14, v142
  v_add_f32 v15, v15, v143
  v_cvt_pk_bf16_f32 v135, v142, v143
  ds_read_b64_tr_b16 v[208:209], v10 offset:24576
  ds_read_b64_tr_b16 v[210:211], v10 offset:26624
  ds_read_b64_tr_b16 v[216:217], v11 offset:24576
  ds_read_b64_tr_b16 v[218:219], v11 offset:26624
  ds_read_b64_tr_b16 v[224:225], v12 offset:24576
  ds_read_b64_tr_b16 v[226:227], v12 offset:26624
  ds_read_b64_tr_b16 v[232:233], v13 offset:24576
  ds_read_b64_tr_b16 v[234:235], v13 offset:26624
  ds_read_b64_tr_b16 v[212:213], v10 offset:28672
  ds_read_b64_tr_b16 v[214:215], v10 offset:30720
  ds_read_b64_tr_b16 v[220:221], v11 offset:28672
  ds_read_b64_tr_b16 v[222:223], v11 offset:30720
  ds_read_b64_tr_b16 v[228:229], v12 offset:28672
  ds_read_b64_tr_b16 v[230:231], v12 offset:30720
  ds_read_b64_tr_b16 v[236:237], v13 offset:28672
  ds_read_b64_tr_b16 v[238:239], v13 offset:30720
  s_waitcnt lgkmcnt(14)
  v_mfma_f32_32x32x16_bf16 v[16:31], v[208:211], v[128:131], v[16:31]
  s_waitcnt lgkmcnt(12)
  v_mfma_f32_32x32x16_bf16 v[32:47], v[216:219], v[128:131], v[32:47]
  s_waitcnt lgkmcnt(10)
  v_mfma_f32_32x32x16_bf16 v[48:63], v[224:227], v[128:131], v[48:63]
  s_waitcnt lgkmcnt(8)
  v_mfma_f32_32x32x16_bf16 v[64:79], v[232:235], v[128:131], v[64:79]
  s_waitcnt lgkmcnt(6)
  v_mfma_f32_32x32x16_bf16 v[16:31], v[212:215], v[132:135], v[16:31]
  s_waitcnt lgkmcnt(4)
  v_mfma_f32_32x32x16_bf16 v[32:47], v[220:223], v[132:135], v[32:47]
  s_waitcnt lgkmcnt(2)
  v_mfma_f32_32x32x16_bf16 v[48:63], v[228:231], v[132:135], v[48:63]
  s_waitcnt lgkmcnt(0)
  v_mfma_f32_32x32x16_bf16 v[64:79], v[236:239], v[132:135], v[64:79]
  s_waitcnt lgkmcnt(0)
  s_add_u32 s39, s37, 32768
  s_cmp_eq_u32 s39, 131072
  s_cselect_b32 s39, 0, s39
  s_sub_u32 s29, s39, s37
  s_mov_b32 s37, s39
  s_mov_b32 s39, s29
  v_add_u32 v2, s39, v2
  v_add_u32 v3, s39, v3
  v_add_u32 v4, s39, v4
  v_add_u32 v5, s39, v5
  v_add_u32 v6, s39, v6
  v_add_u32 v7, s39, v7
  v_add_u32 v8, s39, v8
  v_add_u32 v9, s39, v9
  v_add_u32 v10, s39, v10
  v_add_u32 v11, s39, v11
  v_add_u32 v12, s39, v12
  v_add_u32 v13, s39, v13
  s_sub_u32 s36, s36, 1
  s_cmp_lg_u32 s36, 0
  s_cbranch_scc1 KV_SLOW2
  s_waitcnt lgkmcnt(0)
  s_nop 13
  v_add_f32 v14, v14, v15
  v_mov_b32 v242, v14
  s_nop 1
  v_permlane32_swap_b32 v14, v242
  v_add_f32 v14, v14, v242
  v_rcp_f32 v243, v14
  s_nop 0
  v_mul_f32 v16, v243, v16
  v_mul_f32 v17, v243, v17
  v_mul_f32 v18, v243, v18
  v_mul_f32 v19, v243, v19
  v_mul_f32 v20, v243, v20
  v_mul_f32 v21, v243, v21
  v_mul_f32 v22, v243, v22
  v_mul_f32 v23, v243, v23
  v_cvt_pk_bf16_f32 v144, v16, v17
  v_cvt_pk_bf16_f32 v145, v18, v19
  v_cvt_pk_bf16_f32 v146, v20, v21
  v_cvt_pk_bf16_f32 v147, v22, v23
  buffer_store_dwordx4 v[144:147], v241, s[24:27], 0 offen offset:0
  v_mul_f32 v24, v243, v24
  v_mul_f32 v25, v243, v25
  v_mul_f32 v26, v243, v26
  v_mul_f32 v27, v243, v27
  v_mul_f32 v28, v243, v28
  v_mul_f32 v29, v243, v29
  v_mul_f32 v30, v243, v30
  v_mul_f32 v31, v243, v31
  v_cvt_pk_bf16_f32 v148, v24, v25
  v_cvt_pk_bf16_f32 v149, v26, v27
  v_cvt_pk_bf16_f32 v150, v28, v29
  v_cvt_pk_bf16_f32 v151, v30, v31
  buffer_store_dwordx4 v[148:151], v241, s[24:27], 0 offen offset:1024
  v_mul_f32 v32, v243, v32
  v_mul_f32 v33, v243, v33
  v_mul_f32 v34, v243, v34
  v_mul_f32 v35, v243, v35
  v_mul_f32 v36, v243, v36
  v_mul_f32 v37, v243, v37
  v_mul_f32 v38, v243, v38
  v_mul_f32 v39, v243, v39
  v_cvt_pk_bf16_f32 v152, v32, v33
  v_cvt_pk_bf16_f32 v153, v34, v35
  v_cvt_pk_bf16_f32 v154, v36, v37
  v_cvt_pk_bf16_f32 v155, v38, v39
  buffer_store_dwordx4 v[152:155], v241, s[24:27], 0 offen offset:2048
  v_mul_f32 v40, v243, v40
  v_mul_f32 v41, v243, v41
  v_mul_f32 v42, v243, v42
  v_mul_f32 v43, v243, v43
  v_mul_f32 v44, v243, v44
  v_mul_f32 v45, v243, v45
  v_mul_f32 v46, v243, v46
  v_mul_f32 v47, v243, v47
  v_cvt_pk_bf16_f32 v156, v40, v41
  v_cvt_pk_bf16_f32 v157, v42, v43
  v_cvt_pk_bf16_f32 v158, v44, v45
  v_cvt_pk_bf16_f32 v159, v46, v47
  buffer_store_dwordx4 v[156:159], v241, s[24:27], 0 offen offset:3072
  v_mul_f32 v48, v243, v48
  v_mul_f32 v49, v243, v49
  v_mul_f32 v50, v243, v50
  v_mul_f32 v51, v243, v51
  v_mul_f32 v52, v243, v52
  v_mul_f32 v53, v243, v53
  v_mul_f32 v54, v243, v54
  v_mul_f32 v55, v243, v55
  v_cvt_pk_bf16_f32 v160, v48, v49
  v_cvt_pk_bf16_f32 v161, v50, v51
  v_cvt_pk_bf16_f32 v162, v52, v53
  v_cvt_pk_bf16_f32 v163, v54, v55
  buffer_store_dwordx4 v[160:163], v241, s[24:27], s64 offen offset:0
  v_mul_f32 v56, v243, v56
  v_mul_f32 v57, v243, v57
  v_mul_f32 v58, v243, v58
  v_mul_f32 v59, v243, v59
  v_mul_f32 v60, v243, v60
  v_mul_f32 v61, v243, v61
  v_mul_f32 v62, v243, v62
  v_mul_f32 v63, v243, v63
  v_cvt_pk_bf16_f32 v164, v56, v57
  v_cvt_pk_bf16_f32 v165, v58, v59
  v_cvt_pk_bf16_f32 v166, v60, v61
  v_cvt_pk_bf16_f32 v167, v62, v63
  buffer_store_dwordx4 v[164:167], v241, s[24:27], s64 offen offset:1024
  v_mul_f32 v64, v243, v64
  v_mul_f32 v65, v243, v65
  v_mul_f32 v66, v243, v66
  v_mul_f32 v67, v243, v67
  v_mul_f32 v68, v243, v68
  v_mul_f32 v69, v243, v69
  v_mul_f32 v70, v243, v70
  v_mul_f32 v71, v243, v71
  v_cvt_pk_bf16_f32 v168, v64, v65
  v_cvt_pk_bf16_f32 v169, v66, v67
  v_cvt_pk_bf16_f32 v170, v68, v69
  v_cvt_pk_bf16_f32 v171, v70, v71
  buffer_store_dwordx4 v[168:171], v241, s[24:27], s64 offen offset:2048
  v_mul_f32 v72, v243, v72
  v_mul_f32 v73, v243, v73
  v_mul_f32 v74, v243, v74
  v_mul_f32 v75, v243, v75
  v_mul_f32 v76, v243, v76
  v_mul_f32 v77, v243, v77
  v_mul_f32 v78, v243, v78
  v_mul_f32 v79, v243, v79
  v_cvt_pk_bf16_f32 v172, v72, v73
  v_cvt_pk_bf16_f32 v173, v74, v75
  v_cvt_pk_bf16_f32 v174, v76, v77
  v_cvt_pk_bf16_f32 v175, v78, v79
  buffer_store_dwordx4 v[172:175], v241, s[24:27], s64 offen offset:3072
ITEM_END:
  s_waitcnt lgkmcnt(0)
  s_nop 13
  s_sub_u32 s62, s62, 1
  s_cmp_eq_u32 s62, 0
  s_cbranch_scc1 ITEMS_DONE
  s_xor_b32 s7, s7, 1
  s_branch ITEM2
ITEMS_DONE:
DECIDE:
  s_cmp_lg_u32 s65, 0
  s_cbranch_scc1 NEXT_REDO
  s_barrier
  v_mov_b32 v112, s40
  s_lshl_b32 s28, s3, 2
  v_mov_b32 v113, s28
  ds_write_b32 v113, v112
  s_waitcnt lgkmcnt(0)
  s_barrier
  v_and_b32 v113, 7, v0
  v_lshlrev_b32 v113, 2, v113
  ds_read_b32 v112, v113
  s_waitcnt lgkmcnt(0)
  s_waitcnt lgkmcnt(0)
  v_and_b32 v113, 1, v112
  v_cmp_ne_u32 vcc, 0, v113
  v_and_b32 v113, 2, v112
  s_nop 4
  s_cmp_lg_u64 vcc, 0
  s_cselect_b32 s41, 1, 0
  v_cmp_ne_u32 vcc, 0, v113
  s_nop 4
  s_cmp_lg_u64 vcc, 0
  s_cselect_b32 s28, 2, 0
  s_or_b32 s41, s41, s28
  s_barrier
  s_mov_b32 s65, 2
NEXT_REDO:
  s_cmp_eq_u32 s65, 1
  s_cbranch_scc1 REDO_PASS2
  s_cmp_eq_u32 s41, 0
  s_cbranch_scc1 K1_DONE
  s_and_b32 s28, s41, 1
  s_cselect_b32 s7, 0, 1
  s_cselect_b32 s28, 1, 2
  s_xor_b32 s41, s41, s28
  s_mov_b32 s65, 1
  s_branch REDO_GO
REDO_PASS2:
  s_mov_b32 s65, 2
REDO_GO:
  s_mov_b32 s62, 1
  s_barrier
  s_cmp_eq_u32 s3, 7
  s_cbranch_scc1 LD_STREAM
  s_branch ITEM
K1_DONE:
  s_waitcnt vmcnt(0)
K1_EXIT:
  s_endpgm
.globl oproj_kernel
.p2align 8
.type oproj_kernel,@function
oproj_kernel:
  s_cmp_ge_u32 s2, 224
  s_cbranch_scc1 K2_EXIT
  s_load_dwordx2 s[44:45], s[0:1], 32
  s_load_dwordx2 s[46:47], s[0:1], 72
  s_load_dwordx2 s[48:49], s[0:1], 80
  s_load_dwordx2 s[60:61], s[0:1], 96
  v_lshrrev_b32 v1, 6, v0
  v_and_b32 v0, 63, v0
  s_and_b32 s28, s2, 7
  v_readfirstlane_b32 s3, v1
  s_lshr_b32 s29, s2, 3
  s_mul_i32 s28, s28, 28
  s_add_u32 s28, s28, s29
  s_lshr_b32 s5, s28, 3
  s_and_b32 s4, s28, 7
  s_cmp_ge_u32 s5, 14
  s_cselect_b32 s7, 1, 0
  s_waitcnt lgkmcnt(0)
  s_cselect_b32 s12, s46, s44
  s_cselect_b32 s13, s47, s45
  s_lshl_b32 s28, s3, 20
  s_lshl_b32 s29, s4, 7
  s_add_u32 s28, s28, s29
  s_add_u32 s12, s12, s28
  s_addc_u32 s13, s13, 0
  s_sub_u32 s14, 0x400000, s28
  s_mov_b32 s15, 0x20000
  s_lshl_b32 s28, s5, 20
  s_lshl_b32 s29, s3, 16
  s_add_u32 s28, s28, s29
  s_add_u32 s8, s60, s28
  s_addc_u32 s9, s61, 0
  s_mov_b32 s10, 851968
  s_mov_b32 s11, 0x20000
  s_mul_i32 s28, s7, 14
  s_sub_u32 s28, s5, s28
  s_lshl_b32 s28, s28, 2
  s_add_u32 s28, s28, s3
  s_lshl_b32 s28, s28, 16
  s_lshl_b32 s29, s7, 10
  s_add_u32 s28, s28, s29
  s_lshl_b32 s29, s4, 7
  s_add_u32 s28, s28, s29
  s_add_u32 s16, s48, s28
  s_addc_u32 s17, s49, 0
  s_mov_b32 s18, 63616
  s_mov_b32 s19, 0x20000
  s_mul_i32 s33, s3, 24576
  s_mov_b32 s30, 0
  s_mov_b32 s31, 0
  v_lshlrev_b32 v4, 4, v0
  v_add_u32 v5, 0x40000, v4
  v_add_u32 v6, 0x80000, v4
  v_add_u32 v7, 0xc0000, v4
  v_lshrrev_b32 v208, 3, v0
  v_bfe_u32 v209, v0, 4, 1
  v_lshlrev_b32 v209, 2, v209
  v_and_b32 v210, 7, v0
  v_xor_b32 v209, v209, v210
  v_lshlrev_b32 v209, 4, v209
  v_lshl_add_u32 v8, v208, 10, v209
  v_bfe_u32 v208, v0, 2, 2
  v_lshrrev_b32 v209, 5, v0
  v_lshlrev_b32 v210, 7, v208
  v_lshl_add_u32 v210, v209, 10, v210
  v_bfe_u32 v211, v0, 4, 1
  v_lshl_add_u32 v210, v211, 5, v210
  v_and_b32 v211, 1, v0
  v_lshl_add_u32 v210, v211, 4, v210
  v_bfe_u32 v211, v0, 1, 1
  v_lshl_add_u32 v210, v211, 3, v210
  v_add_u32 v210, s33, v210
  v_lshrrev_b32 v208, 1, v208
  v_lshl_add_u32 v2, v208, 6, v210
  v_xor_b32 v208, 1, v208
  v_lshl_add_u32 v3, v208, 6, v210
  v_and_b32 v208, 31, v0
  v_lshlrev_b32 v208, 11, v208
  v_lshl_add_u32 v9, v209, 4, v208
  s_add_u32 m0, s33, 0
  s_mov_b32 s32, 0
  buffer_load_dwordx4 v8, s[12:15], s32 offen lds
  s_add_u32 m0, s33, 1024
  s_mov_b32 s32, 8192
  buffer_load_dwordx4 v8, s[12:15], s32 offen lds
  s_add_u32 m0, s33, 2048
  s_mov_b32 s32, 16384
  buffer_load_dwordx4 v8, s[12:15], s32 offen lds
  s_add_u32 m0, s33, 3072
  s_mov_b32 s32, 24576
  buffer_load_dwordx4 v8, s[12:15], s32 offen lds
  s_mov_b32 s30, 0
  buffer_load_dwordx4 v[16:19], v4, s[8:11], s30 offen
  buffer_load_dwordx4 v[20:23], v5, s[8:11], s30 offen
  buffer_load_dwordx4 v[24:27], v6, s[8:11], s30 offen
  buffer_load_dwordx4 v[28:31], v7, s[8:11], s30 offen
  s_mov_b32 s30, 1024
  buffer_load_dwordx4 v[32:35], v4, s[8:11], s30 offen
  buffer_load_dwordx4 v[36:39], v5, s[8:11], s30 offen
  buffer_load_dwordx4 v[40:43], v6, s[8:11], s30 offen
  buffer_load_dwordx4 v[44:47], v7, s[8:11], s30 offen
  s_add_u32 m0, s33, 4096
  s_mov_b32 s32, 32768
  buffer_load_dwordx4 v8, s[12:15], s32 offen lds
  s_add_u32 m0, s33, 5120
  s_mov_b32 s32, 40960
  buffer_load_dwordx4 v8, s[12:15], s32 offen lds
  s_add_u32 m0, s33, 6144
  s_mov_b32 s32, 49152
  buffer_load_dwordx4 v8, s[12:15], s32 offen lds
  s_add_u32 m0, s33, 7168
  s_mov_b32 s32, 57344
  buffer_load_dwordx4 v8, s[12:15], s32 offen lds
  s_mov_b32 s30, 2048
  buffer_load_dwordx4 v[48:51], v4, s[8:11], s30 offen
  buffer_load_dwordx4 v[52:55], v5, s[8:11], s30 offen
  buffer_load_dwordx4 v[56:59], v6, s[8:11], s30 offen
  buffer_load_dwordx4 v[60:63], v7, s[8:11], s30 offen
  s_mov_b32 s30, 3072
  buffer_load_dwordx4 v[64:67], v4, s[8:11], s30 offen
  buffer_load_dwordx4 v[68:71], v5, s[8:11], s30 offen
  buffer_load_dwordx4 v[72:75], v6, s[8:11], s30 offen
  buffer_load_dwordx4 v[76:79], v7, s[8:11], s30 offen
  s_add_u32 m0, s33, 8192
  s_mov_b32 s32, 65536
  buffer_load_dwordx4 v8, s[12:15], s32 offen lds
  s_add_u32 m0, s33, 9216
  s_mov_b32 s32, 73728
  buffer_load_dwordx4 v8, s[12:15], s32 offen lds
  s_add_u32 m0, s33, 10240
  s_mov_b32 s32, 81920
  buffer_load_dwordx4 v8, s[12:15], s32 offen lds
  s_add_u32 m0, s33, 11264
  s_mov_b32 s32, 90112
  buffer_load_dwordx4 v8, s[12:15], s32 offen lds
  s_mov_b32 s30, 4096
  buffer_load_dwordx4 v[80:83], v4, s[8:11], s30 offen
  buffer_load_dwordx4 v[84:87], v5, s[8:11], s30 offen
  buffer_load_dwordx4 v[88:91], v6, s[8:11], s30 offen
  buffer_load_dwordx4 v[92:95], v7, s[8:11], s30 offen
  s_mov_b32 s30, 5120
  buffer_load_dwordx4 v[96:99], v4, s[8:11], s30 offen
  buffer_load_dwordx4 v[100:103], v5, s[8:11], s30 offen
  buffer_load_dwordx4 v[104:107], v6, s[8:11], s30 offen
  buffer_load_dwordx4 v[108:111], v7, s[8:11], s30 offen
  s_add_u32 m0, s33, 12288
  s_mov_b32 s32, 98304
  buffer_load_dwordx4 v8, s[12:15], s32 offen lds
  s_add_u32 m0, s33, 13312
  s_mov_b32 s32, 106496
  buffer_load_dwordx4 v8, s[12:15], s32 offen lds
  s_add_u32 m0, s33, 14336
  s_mov_b32 s32, 114688
  buffer_load_dwordx4 v8, s[12:15], s32 offen lds
  s_add_u32 m0, s33, 15360
  s_mov_b32 s32, 122880
  buffer_load_dwordx4 v8, s[12:15], s32 offen lds
  s_mov_b32 s30, 6144
  buffer_load_dwordx4 v[112:115], v4, s[8:11], s30 offen
  buffer_load_dwordx4 v[116:119], v5, s[8:11], s30 offen
  buffer_load_dwordx4 v[120:123], v6, s[8:11], s30 offen
  buffer_load_dwordx4 v[124:127], v7, s[8:11], s30 offen
  s_mov_b32 s30, 7168
  buffer_load_dwordx4 v[128:131], v4, s[8:11], s30 offen
  buffer_load_dwordx4 v[132:135], v5, s[8:11], s30 offen
  buffer_load_dwordx4 v[136:139], v6, s[8:11], s30 offen
  buffer_load_dwordx4 v[140:143], v7, s[8:11], s30 offen
  s_add_u32 m0, s33, 16384
  s_mov_b32 s32, 131072
  buffer_load_dwordx4 v8, s[12:15], s32 offen lds
  s_add_u32 m0, s33, 17408
  s_mov_b32 s32, 139264
  buffer_load_dwordx4 v8, s[12:15], s32 offen lds
  s_add_u32 m0, s33, 18432
  s_mov_b32 s32, 147456
  buffer_load_dwordx4 v8, s[12:15], s32 offen lds
  s_add_u32 m0, s33, 19456
  s_mov_b32 s32, 155648
  buffer_load_dwordx4 v8, s[12:15], s32 offen lds
  s_mov_b32 s30, 8192
  buffer_load_dwordx4 v[144:147], v4, s[8:11], s30 offen
  buffer_load_dwordx4 v[148:151], v5, s[8:11], s30 offen
  buffer_load_dwordx4 v[152:155], v6, s[8:11], s30 offen
  buffer_load_dwordx4 v[156:159], v7, s[8:11], s30 offen
  s_mov_b32 s30, 9216
  buffer_load_dwordx4 v[160:163], v4, s[8:11], s30 offen
  buffer_load_dwordx4 v[164:167], v5, s[8:11], s30 offen
  buffer_load_dwordx4 v[168:171], v6, s[8:11], s30 offen
  buffer_load_dwordx4 v[172:175], v7, s[8:11], s30 offen
  s_add_u32 m0, s33, 20480
  s_mov_b32 s32, 163840
  buffer_load_dwordx4 v8, s[12:15], s32 offen lds
  s_add_u32 m0, s33, 21504
  s_mov_b32 s32, 172032
  buffer_load_dwordx4 v8, s[12:15], s32 offen lds
  s_add_u32 m0, s33, 22528
  s_mov_b32 s32, 180224
  buffer_load_dwordx4 v8, s[12:15], s32 offen lds
  s_add_u32 m0, s33, 23552
  s_mov_b32 s32, 188416
  buffer_load_dwordx4 v8, s[12:15], s32 offen lds
  s_waitcnt vmcnt(60)
  ds_read_b64_tr_b16 v[176:177], v2 offset:0
  ds_read_b64_tr_b16 v[178:179], v2 offset:512
  ds_read_b64_tr_b16 v[180:181], v3 offset:0
  ds_read_b64_tr_b16 v[182:183], v3 offset:512
  ds_read_b64_tr_b16 v[184:185], v2 offset:2048
  ds_read_b64_tr_b16 v[186:187], v2 offset:2560
  ds_read_b64_tr_b16 v[188:189], v3 offset:2048
  ds_read_b64_tr_b16 v[190:191], v3 offset:2560
  s_waitcnt vmcnt(48)
  s_waitcnt lgkmcnt(6)
  v_mfma_f32_32x32x16_bf16 a[0:15], v[176:179], v[16:19], 0
  ds_read_b64_tr_b16 v[192:193], v2 offset:4096
  s_waitcnt lgkmcnt(5)
  v_mfma_f32_32x32x16_bf16 a[16:31], v[180:183], v[16:19], 0
  ds_read_b64_tr_b16 v[194:195], v2 offset:4608
  v_mfma_f32_32x32x16_bf16 a[32:47], v[176:179], v[20:23], 0
  ds_read_b64_tr_b16 v[196:197], v3 offset:4096
  v_mfma_f32_32x32x16_bf16 a[48:63], v[180:183], v[20:23], 0
  ds_read_b64_tr_b16 v[198:199], v3 offset:4608
  v_mfma_f32_32x32x16_bf16 a[64:79], v[176:179], v[24:27], 0
  ds_read_b64_tr_b16 v[200:201], v2 offset:6144
  v_mfma_f32_32x32x16_bf16 a[80:95], v[180:183], v[24:27], 0
  ds_read_b64_tr_b16 v[202:203], v2 offset:6656
  v_mfma_f32_32x32x16_bf16 a[96:111], v[176:179], v[28:31], 0
  ds_read_b64_tr_b16 v[204:205], v3 offset:6144
  v_mfma_f32_32x32x16_bf16 a[112:127], v[180:183], v[28:31], 0
  ds_read_b64_tr_b16 v[206:207], v3 offset:6656
  s_mov_b32 s30, 10240
  buffer_load_dwordx4 v[16:19], v4, s[8:11], s30 offen
  buffer_load_dwordx4 v[20:23], v5, s[8:11], s30 offen
  buffer_load_dwordx4 v[24:27], v6, s[8:11], s30 offen
  buffer_load_dwordx4 v[28:31], v7, s[8:11], s30 offen
  s_waitcnt lgkmcnt(10)
  v_mfma_f32_32x32x16_bf16 a[0:15], v[184:187], v[32:35], a[0:15]
  s_waitcnt lgkmcnt(8)
  v_mfma_f32_32x32x16_bf16 a[16:31], v[188:191], v[32:35], a[16:31]
  v_mfma_f32_32x32x16_bf16 a[32:47], v[184:187], v[36:39], a[32:47]
  v_mfma_f32_32x32x16_bf16 a[48:63], v[188:191], v[36:39], a[48:63]
  v_mfma_f32_32x32x16_bf16 a[64:79], v[184:187], v[40:43], a[64:79]
  v_mfma_f32_32x32x16_bf16 a[80:95], v[188:191], v[40:43], a[80:95]
  v_mfma_f32_32x32x16_bf16 a[96:111], v[184:187], v[44:47], a[96:111]
  v_mfma_f32_32x32x16_bf16 a[112:127], v[188:191], v[44:47], a[112:127]
  s_mov_b32 s30, 11264
  buffer_load_dwordx4 v[32:35], v4, s[8:11], s30 offen
  buffer_load_dwordx4 v[36:39], v5, s[8:11], s30 offen
  buffer_load_dwordx4 v[40:43], v6, s[8:11], s30 offen
  buffer_load_dwordx4 v[44:47], v7, s[8:11], s30 offen
  s_add_u32 m0, s33, 0
  s_mov_b32 s32, 196608
  buffer_load_dwordx4 v8, s[12:15], s32 offen lds
  s_add_u32 m0, s33, 1024
  s_mov_b32 s32, 204800
  buffer_load_dwordx4 v8, s[12:15], s32 offen lds
  s_add_u32 m0, s33, 2048
  s_mov_b32 s32, 212992
  buffer_load_dwordx4 v8, s[12:15], s32 offen lds
  s_add_u32 m0, s33, 3072
  s_mov_b32 s32, 221184
  buffer_load_dwordx4 v8, s[12:15], s32 offen lds
  s_waitcnt vmcnt(48)
  s_waitcnt lgkmcnt(6)
  v_mfma_f32_32x32x16_bf16 a[0:15], v[192:195], v[48:51], a[0:15]
  ds_read_b64_tr_b16 v[176:177], v2 offset:8192
  s_waitcnt lgkmcnt(5)
  v_mfma_f32_32x32x16_bf16 a[16:31], v[196:199], v[48:51], a[16:31]
  ds_read_b64_tr_b16 v[178:179], v2 offset:8704
  v_mfma_f32_32x32x16_bf16 a[32:47], v[192:195], v[52:55], a[32:47]
  ds_read_b64_tr_b16 v[180:181], v3 offset:8192
  v_mfma_f32_32x32x16_bf16 a[48:63], v[196:199], v[52:55], a[48:63]
  ds_read_b64_tr_b16 v[182:183], v3 offset:8704
  v_mfma_f32_32x32x16_bf16 a[64:79], v[192:195], v[56:59], a[64:79]
  ds_read_b64_tr_b16 v[184:185], v2 offset:10240
  v_mfma_f32_32x32x16_bf16 a[80:95], v[196:199], v[56:59], a[80:95]
  ds_read_b64_tr_b16 v[186:187], v2 offset:10752
  v_mfma_f32_32x32x16_bf16 a[96:111], v[192:195], v[60:63], a[96:111]
  ds_read_b64_tr_b16 v[188:189], v3 offset:10240
  v_mfma_f32_32x32x16_bf16 a[112:127], v[196:199], v[60:63], a[112:127]
  ds_read_b64_tr_b16 v[190:191], v3 offset:10752
  s_mov_b32 s30, 12288
  buffer_load_dwordx4 v[48:51], v4, s[8:11], s30 offen
  buffer_load_dwordx4 v[52:55], v5, s[8:11], s30 offen
  buffer_load_dwordx4 v[56:59], v6, s[8:11], s30 offen
  buffer_load_dwordx4 v[60:63], v7, s[8:11], s30 offen
  s_waitcnt lgkmcnt(10)
  v_mfma_f32_32x32x16_bf16 a[0:15], v[200:203], v[64:67], a[0:15]
  s_waitcnt lgkmcnt(8)
  v_mfma_f32_32x32x16_bf16 a[16:31], v[204:207], v[64:67], a[16:31]
  v_mfma_f32_32x32x16_bf16 a[32:47], v[200:203], v[68:71], a[32:47]
  v_mfma_f32_32x32x16_bf16 a[48:63], v[204:207], v[68:71], a[48:63]
  v_mfma_f32_32x32x16_bf16 a[64:79], v[200:203], v[72:75], a[64:79]
  v_mfma_f32_32x32x16_bf16 a[80:95], v[204:207], v[72:75], a[80:95]
  v_mfma_f32_32x32x16_bf16 a[96:111], v[200:203], v[76:79], a[96:111]
  v_mfma_f32_32x32x16_bf16 a[112:127], v[204:207], v[76:79], a[112:127]
  s_mov_b32 s30, 13312
  buffer_load_dwordx4 v[64:67], v4, s[8:11], s30 offen
  buffer_load_dwordx4 v[68:71], v5, s[8:11], s30 offen
  buffer_load_dwordx4 v[72:75], v6, s[8:11], s30 offen
  buffer_load_dwordx4 v[76:79], v7, s[8:11], s30 offen
  s_add_u32 m0, s33, 4096
  s_mov_b32 s32, 229376
  buffer_load_dwordx4 v8, s[12:15], s32 offen lds
  s_add_u32 m0, s33, 5120
  s_mov_b32 s32, 237568
  buffer_load_dwordx4 v8, s[12:15], s32 offen lds
  s_add_u32 m0, s33, 6144
  s_mov_b32 s32, 245760
  buffer_load_dwordx4 v8, s[12:15], s32 offen lds
  s_add_u32 m0, s33, 7168
  s_mov_b32 s32, 253952
  buffer_load_dwordx4 v8, s[12:15], s32 offen lds
  s_waitcnt vmcnt(48)
  s_waitcnt lgkmcnt(6)
  v_mfma_f32_32x32x16_bf16 a[0:15], v[176:179], v[80:83], a[0:15]
  ds_read_b64_tr_b16 v[192:193], v2 offset:12288
  s_waitcnt lgkmcnt(5)
  v_mfma_f32_32x32x16_bf16 a[16:31], v[180:183], v[80:83], a[16:31]
  ds_read_b64_tr_b16 v[194:195], v2 offset:12800
  v_mfma_f32_32x32x16_bf16 a[32:47], v[176:179], v[84:87], a[32:47]
  ds_read_b64_tr_b16 v[196:197], v3 offset:12288
  v_mfma_f32_32x32x16_bf16 a[48:63], v[180:183], v[84:87], a[48:63]
  ds_read_b64_tr_b16 v[198:199], v3 offset:12800
  v_mfma_f32_32x32x16_bf16 a[64:79], v[176:179], v[88:91], a[64:79]
  ds_read_b64_tr_b16 v[200:201], v2 offset:14336
  v_mfma_f32_32x32x16_bf16 a[80:95], v[180:183], v[88:91], a[80:95]
  ds_read_b64_tr_b16 v[202:203], v2 offset:14848
  v_mfma_f32_32x32x16_bf16 a[96:111], v[176:179], v[92:95], a[96:111]
  ds_read_b64_tr_b16 v[204:205], v3 offset:14336
  v_mfma_f32_32x32x16_bf16 a[112:127], v[180:183], v[92:95], a[112:127]
  ds_read_b64_tr_b16 v[206:207], v3 offset:14848
  s_mov_b32 s30, 14336
  buffer_load_dwordx4 v[80:83], v4, s[8:11], s30 offen
  buffer_load_dwordx4 v[84:87], v5, s[8:11], s30 offen
  buffer_load_dwordx4 v[88:91], v6, s[8:11], s30 offen
  buffer_load_dwordx4 v[92:95], v7, s[8:11], s30 offen
  s_waitcnt lgkmcnt(10)
  v_mfma_f32_32x32x16_bf16 a[0:15], v[184:187], v[96:99], a[0:15]
  s_waitcnt lgkmcnt(8)
  v_mfma_f32_32x32x16_bf16 a[16:31], v[188:191], v[96:99], a[16:31]
  v_mfma_f32_32x32x16_bf16 a[32:47], v[184:187], v[100:103], a[32:47]
  v_mfma_f32_32x32x16_bf16 a[48:63], v[188:191], v[100:103], a[48:63]
  v_mfma_f32_32x32x16_bf16 a[64:79], v[184:187], v[104:107], a[64:79]
  v_mfma_f32_32x32x16_bf16 a[80:95], v[188:191], v[104:107], a[80:95]
  v_mfma_f32_32x32x16_bf16 a[96:111], v[184:187], v[108:111], a[96:111]
  v_mfma_f32_32x32x16_bf16 a[112:127], v[188:191], v[108:111], a[112:127]
  s_mov_b32 s30, 15360
  buffer_load_dwordx4 v[96:99], v4, s[8:11], s30 offen
  buffer_load_dwordx4 v[100:103], v5, s[8:11], s30 offen
  buffer_load_dwordx4 v[104:107], v6, s[8:11], s30 offen
  buffer_load_dwordx4 v[108:111], v7, s[8:11], s30 offen
  s_add_u32 m0, s33, 8192
  s_mov_b32 s32, 262144
  buffer_load_dwordx4 v8, s[12:15], s32 offen lds
  s_add_u32 m0, s33, 9216
  s_mov_b32 s32, 270336
  buffer_load_dwordx4 v8, s[12:15], s32 offen lds
  s_add_u32 m0, s33, 10240
  s_mov_b32 s32, 278528
  buffer_load_dwordx4 v8, s[12:15], s32 offen lds
  s_add_u32 m0, s33, 11264
  s_mov_b32 s32, 286720
  buffer_load_dwordx4 v8, s[12:15], s32 offen lds
  s_waitcnt vmcnt(48)
  s_waitcnt lgkmcnt(6)
  v_mfma_f32_32x32x16_bf16 a[0:15], v[192:195], v[112:115], a[0:15]
  ds_read_b64_tr_b16 v[176:177], v2 offset:16384
  s_waitcnt lgkmcnt(5)
  v_mfma_f32_32x32x16_bf16 a[16:31], v[196:199], v[112:115], a[16:31]
  ds_read_b64_tr_b16 v[178:179], v2 offset:16896
  v_mfma_f32_32x32x16_bf16 a[32:47], v[192:195], v[116:119], a[32:47]
  ds_read_b64_tr_b16 v[180:181], v3 offset:16384
  v_mfma_f32_32x32x16_bf16 a[48:63], v[196:199], v[116:119], a[48:63]
  ds_read_b64_tr_b16 v[182:183], v3 offset:16896
  v_mfma_f32_32x32x16_bf16 a[64:79], v[192:195], v[120:123], a[64:79]
  ds_read_b64_tr_b16 v[184:185], v2 offset:18432
  v_mfma_f32_32x32x16_bf16 a[80:95], v[196:199], v[120:123], a[80:95]
  ds_read_b64_tr_b16 v[186:187], v2 offset:18944
  v_mfma_f32_32x32x16_bf16 a[96:111], v[192:195], v[124:127], a[96:111]
  ds_read_b64_tr_b16 v[188:189], v3 offset:18432
  v_mfma_f32_32x32x16_bf16 a[112:127], v[196:199], v[124:127], a[112:127]
  ds_read_b64_tr_b16 v[190:191], v3 offset:18944
  s_mov_b32 s30, 16384
  buffer_load_dwordx4 v[112:115], v4, s[8:11], s30 offen
  buffer_load_dwordx4 v[116:119], v5, s[8:11], s30 offen
  buffer_load_dwordx4 v[120:123], v6, s[8:11], s30 offen
  buffer_load_dwordx4 v[124:127], v7, s[8:11], s30 offen
  s_waitcnt lgkmcnt(10)
  v_mfma_f32_32x32x16_bf16 a[0:15], v[200:203], v[128:131], a[0:15]
  s_waitcnt lgkmcnt(8)
  v_mfma_f32_32x32x16_bf16 a[16:31], v[204:207], v[128:131], a[16:31]
  v_mfma_f32_32x32x16_bf16 a[32:47], v[200:203], v[132:135], a[32:47]
  v_mfma_f32_32x32x16_bf16 a[48:63], v[204:207], v[132:135], a[48:63]
  v_mfma_f32_32x32x16_bf16 a[64:79], v[200:203], v[136:139], a[64:79]
  v_mfma_f32_32x32x16_bf16 a[80:95], v[204:207], v[136:139], a[80:95]
  v_mfma_f32_32x32x16_bf16 a[96:111], v[200:203], v[140:143], a[96:111]
  v_mfma_f32_32x32x16_bf16 a[112:127], v[204:207], v[140:143], a[112:127]
  s_mov_b32 s30, 17408
  buffer_load_dwordx4 v[128:131], v4, s[8:11], s30 offen
  buffer_load_dwordx4 v[132:135], v5, s[8:11], s30 offen
  buffer_load_dwordx4 v[136:139], v6, s[8:11], s30 offen
  buffer_load_dwordx4 v[140:143], v7, s[8:11], s30 offen
  s_add_u32 m0, s33, 12288
  s_mov_b32 s32, 294912
  buffer_load_dwordx4 v8, s[12:15], s32 offen lds
  s_add_u32 m0, s33, 13312
  s_mov_b32 s32, 303104
  buffer_load_dwordx4 v8, s[12:15], s32 offen lds
  s_add_u32 m0, s33, 14336
  s_mov_b32 s32, 311296
  buffer_load_dwordx4 v8, s[12:15], s32 offen lds
  s_add_u32 m0, s33, 15360
  s_mov_b32 s32, 319488
  buffer_load_dwordx4 v8, s[12:15], s32 offen lds
  s_waitcnt vmcnt(48)
  s_waitcnt lgkmcnt(6)
  v_mfma_f32_32x32x16_bf16 a[0:15], v[176:179], v[144:147], a[0:15]
  ds_read_b64_tr_b16 v[192:193], v2 offset:20480
  s_waitcnt lgkmcnt(5)
  v_mfma_f32_32x32x16_bf16 a[16:31], v[180:183], v[144:147], a[16:31]
  ds_read_b64_tr_b16 v[194:195], v2 offset:20992
  v_mfma_f32_32x32x16_bf16 a[32:47], v[176:179], v[148:151], a[32:47]
  ds_read_b64_tr_b16 v[196:197], v3 offset:20480
  v_mfma_f32_32x32x16_bf16 a[48:63], v[180:183], v[148:151], a[48:63]
  ds_read_b64_tr_b16 v[198:199], v3 offset:20992
  v_mfma_f32_32x32x16_bf16 a[64:79], v[176:179], v[152:155], a[64:79]
  ds_read_b64_tr_b16 v[200:201], v2 offset:22528
  v_mfma_f32_32x32x16_bf16 a[80:95], v[180:183], v[152:155], a[80:95]
  ds_read_b64_tr_b16 v[202:203], v2 offset:23040
  v_mfma_f32_32x32x16_bf16 a[96:111], v[176:179], v[156:159], a[96:111]
  ds_read_b64_tr_b16 v[204:205], v3 offset:22528
  v_mfma_f32_32x32x16_bf16 a[112:127], v[180:183], v[156:159], a[112:127]
  ds_read_b64_tr_b16 v[206:207], v3 offset:23040
  s_mov_b32 s30, 18432
  buffer_load_dwordx4 v[144:147], v4, s[8:11], s30 offen
  buffer_load_dwordx4 v[148:151], v5, s[8:11], s30 offen
  buffer_load_dwordx4 v[152:155], v6, s[8:11], s30 offen
  buffer_load_dwordx4 v[156:159], v7, s[8:11], s30 offen
  s_waitcnt lgkmcnt(10)
  v_mfma_f32_32x32x16_bf16 a[0:15], v[184:187], v[160:163], a[0:15]
  s_waitcnt lgkmcnt(8)
  v_mfma_f32_32x32x16_bf16 a[16:31], v[188:191], v[160:163], a[16:31]
  v_mfma_f32_32x32x16_bf16 a[32:47], v[184:187], v[164:167], a[32:47]
  v_mfma_f32_32x32x16_bf16 a[48:63], v[188:191], v[164:167], a[48:63]
  v_mfma_f32_32x32x16_bf16 a[64:79], v[184:187], v[168:171], a[64:79]
  v_mfma_f32_32x32x16_bf16 a[80:95], v[188:191], v[168:171], a[80:95]
  v_mfma_f32_32x32x16_bf16 a[96:111], v[184:187], v[172:175], a[96:111]
  v_mfma_f32_32x32x16_bf16 a[112:127], v[188:191], v[172:175], a[112:127]
  s_mov_b32 s30, 19456
  buffer_load_dwordx4 v[160:163], v4, s[8:11], s30 offen
  buffer_load_dwordx4 v[164:167], v5, s[8:11], s30 offen
  buffer_load_dwordx4 v[168:171], v6, s[8:11], s30 offen
  buffer_load_dwordx4 v[172:175], v7, s[8:11], s30 offen
  s_add_u32 m0, s33, 16384
  s_mov_b32 s32, 327680
  buffer_load_dwordx4 v8, s[12:15], s32 offen lds
  s_add_u32 m0, s33, 17408
  s_mov_b32 s32, 335872
  buffer_load_dwordx4 v8, s[12:15], s32 offen lds
  s_add_u32 m0, s33, 18432
  s_mov_b32 s32, 344064
  buffer_load_dwordx4 v8, s[12:15], s32 offen lds
  s_add_u32 m0, s33, 19456
  s_mov_b32 s32, 352256
  buffer_load_dwordx4 v8, s[12:15], s32 offen lds
  s_waitcnt vmcnt(48)
  s_waitcnt lgkmcnt(6)
  v_mfma_f32_32x32x16_bf16 a[0:15], v[192:195], v[16:19], a[0:15]
  ds_read_b64_tr_b16 v[176:177], v2 offset:0
  s_waitcnt lgkmcnt(5)
  v_mfma_f32_32x32x16_bf16 a[16:31], v[196:199], v[16:19], a[16:31]
  ds_read_b64_tr_b16 v[178:179], v2 offset:512
  v_mfma_f32_32x32x16_bf16 a[32:47], v[192:195], v[20:23], a[32:47]
  ds_read_b64_tr_b16 v[180:181], v3 offset:0
  v_mfma_f32_32x32x16_bf16 a[48:63], v[196:199], v[20:23], a[48:63]
  ds_read_b64_tr_b16 v[182:183], v3 offset:512
  v_mfma_f32_32x32x16_bf16 a[64:79], v[192:195], v[24:27], a[64:79]
  ds_read_b64_tr_b16 v[184:185], v2 offset:2048
  v_mfma_f32_32x32x16_bf16 a[80:95], v[196:199], v[24:27], a[80:95]
  ds_read_b64_tr_b16 v[186:187], v2 offset:2560
  v_mfma_f32_32x32x16_bf16 a[96:111], v[192:195], v[28:31], a[96:111]
  ds_read_b64_tr_b16 v[188:189], v3 offset:2048
  v_mfma_f32_32x32x16_bf16 a[112:127], v[196:199], v[28:31], a[112:127]
  ds_read_b64_tr_b16 v[190:191], v3 offset:2560
  s_mov_b32 s30, 20480
  buffer_load_dwordx4 v[16:19], v4, s[8:11], s30 offen
  buffer_load_dwordx4 v[20:23], v5, s[8:11], s30 offen
  buffer_load_dwordx4 v[24:27], v6, s[8:11], s30 offen
  buffer_load_dwordx4 v[28:31], v7, s[8:11], s30 offen
  s_waitcnt lgkmcnt(10)
  v_mfma_f32_32x32x16_bf16 a[0:15], v[200:203], v[32:35], a[0:15]
  s_waitcnt lgkmcnt(8)
  v_mfma_f32_32x32x16_bf16 a[16:31], v[204:207], v[32:35], a[16:31]
  v_mfma_f32_32x32x16_bf16 a[32:47], v[200:203], v[36:39], a[32:47]
  v_mfma_f32_32x32x16_bf16 a[48:63], v[204:207], v[36:39], a[48:63]
  v_mfma_f32_32x32x16_bf16 a[64:79], v[200:203], v[40:43], a[64:79]
  v_mfma_f32_32x32x16_bf16 a[80:95], v[204:207], v[40:43], a[80:95]
  v_mfma_f32_32x32x16_bf16 a[96:111], v[200:203], v[44:47], a[96:111]
  v_mfma_f32_32x32x16_bf16 a[112:127], v[204:207], v[44:47], a[112:127]
  s_mov_b32 s30, 21504
  buffer_load_dwordx4 v[32:35], v4, s[8:11], s30 offen
  buffer_load_dwordx4 v[36:39], v5, s[8:11], s30 offen
  buffer_load_dwordx4 v[40:43], v6, s[8:11], s30 offen
  buffer_load_dwordx4 v[44:47], v7, s[8:11], s30 offen
  s_add_u32 m0, s33, 20480
  s_mov_b32 s32, 360448
  buffer_load_dwordx4 v8, s[12:15], s32 offen lds
  s_add_u32 m0, s33, 21504
  s_mov_b32 s32, 368640
  buffer_load_dwordx4 v8, s[12:15], s32 offen lds
  s_add_u32 m0, s33, 22528
  s_mov_b32 s32, 376832
  buffer_load_dwordx4 v8, s[12:15], s32 offen lds
  s_add_u32 m0, s33, 23552
  s_mov_b32 s32, 385024
  buffer_load_dwordx4 v8, s[12:15], s32 offen lds
  s_waitcnt vmcnt(48)
  s_waitcnt lgkmcnt(6)
  v_mfma_f32_32x32x16_bf16 a[0:15], v[176:179], v[48:51], a[0:15]
  ds_read_b64_tr_b16 v[192:193], v2 offset:4096
  s_waitcnt lgkmcnt(5)
  v_mfma_f32_32x32x16_bf16 a[16:31], v[180:183], v[48:51], a[16:31]
  ds_read_b64_tr_b16 v[194:195], v2 offset:4608
  v_mfma_f32_32x32x16_bf16 a[32:47], v[176:179], v[52:55], a[32:47]
  ds_read_b64_tr_b16 v[196:197], v3 offset:4096
  v_mfma_f32_32x32x16_bf16 a[48:63], v[180:183], v[52:55], a[48:63]
  ds_read_b64_tr_b16 v[198:199], v3 offset:4608
  v_mfma_f32_32x32x16_bf16 a[64:79], v[176:179], v[56:59], a[64:79]
  ds_read_b64_tr_b16 v[200:201], v2 offset:6144
  v_mfma_f32_32x32x16_bf16 a[80:95], v[180:183], v[56:59], a[80:95]
  ds_read_b64_tr_b16 v[202:203], v2 offset:6656
  v_mfma_f32_32x32x16_bf16 a[96:111], v[176:179], v[60:63], a[96:111]
  ds_read_b64_tr_b16 v[204:205], v3 offset:6144
  v_mfma_f32_32x32x16_bf16 a[112:127], v[180:183], v[60:63], a[112:127]
  ds_read_b64_tr_b16 v[206:207], v3 offset:6656
  s_mov_b32 s30, 22528
  buffer_load_dwordx4 v[48:51], v4, s[8:11], s30 offen
  buffer_load_dwordx4 v[52:55], v5, s[8:11], s30 offen
  buffer_load_dwordx4 v[56:59], v6, s[8:11], s30 offen
  buffer_load_dwordx4 v[60:63], v7, s[8:11], s30 offen
  s_waitcnt lgkmcnt(10)
  v_mfma_f32_32x32x16_bf16 a[0:15], v[184:187], v[64:67], a[0:15]
  s_waitcnt lgkmcnt(8)
  v_mfma_f32_32x32x16_bf16 a[16:31], v[188:191], v[64:67], a[16:31]
  v_mfma_f32_32x32x16_bf16 a[32:47], v[184:187], v[68:71], a[32:47]
  v_mfma_f32_32x32x16_bf16 a[48:63], v[188:191], v[68:71], a[48:63]
  v_mfma_f32_32x32x16_bf16 a[64:79], v[184:187], v[72:75], a[64:79]
  v_mfma_f32_32x32x16_bf16 a[80:95], v[188:191], v[72:75], a[80:95]
  v_mfma_f32_32x32x16_bf16 a[96:111], v[184:187], v[76:79], a[96:111]
  v_mfma_f32_32x32x16_bf16 a[112:127], v[188:191], v[76:79], a[112:127]
  s_mov_b32 s30, 23552
  buffer_load_dwordx4 v[64:67], v4, s[8:11], s30 offen
  buffer_load_dwordx4 v[68:71], v5, s[8:11], s30 offen
  buffer_load_dwordx4 v[72:75], v6, s[8:11], s30 offen
  buffer_load_dwordx4 v[76:79], v7, s[8:11], s30 offen
  s_add_u32 m0, s33, 0
  s_mov_b32 s32, 393216
  buffer_load_dwordx4 v8, s[12:15], s32 offen lds
  s_add_u32 m0, s33, 1024
  s_mov_b32 s32, 401408
  buffer_load_dwordx4 v8, s[12:15], s32 offen lds
  s_add_u32 m0, s33, 2048
  s_mov_b32 s32, 409600
  buffer_load_dwordx4 v8, s[12:15], s32 offen lds
  s_add_u32 m0, s33, 3072
  s_mov_b32 s32, 417792
  buffer_load_dwordx4 v8, s[12:15], s32 offen lds
  s_waitcnt vmcnt(48)
  s_waitcnt lgkmcnt(6)
  v_mfma_f32_32x32x16_bf16 a[0:15], v[192:195], v[80:83], a[0:15]
  ds_read_b64_tr_b16 v[176:177], v2 offset:8192
  s_waitcnt lgkmcnt(5)
  v_mfma_f32_32x32x16_bf16 a[16:31], v[196:199], v[80:83], a[16:31]
  ds_read_b64_tr_b16 v[178:179], v2 offset:8704
  v_mfma_f32_32x32x16_bf16 a[32:47], v[192:195], v[84:87], a[32:47]
  ds_read_b64_tr_b16 v[180:181], v3 offset:8192
  v_mfma_f32_32x32x16_bf16 a[48:63], v[196:199], v[84:87], a[48:63]
  ds_read_b64_tr_b16 v[182:183], v3 offset:8704
  v_mfma_f32_32x32x16_bf16 a[64:79], v[192:195], v[88:91], a[64:79]
  ds_read_b64_tr_b16 v[184:185], v2 offset:10240
  v_mfma_f32_32x32x16_bf16 a[80:95], v[196:199], v[88:91], a[80:95]
  ds_read_b64_tr_b16 v[186:187], v2 offset:10752
  v_mfma_f32_32x32x16_bf16 a[96:111], v[192:195], v[92:95], a[96:111]
  ds_read_b64_tr_b16 v[188:189], v3 offset:10240
  v_mfma_f32_32x32x16_bf16 a[112:127], v[196:199], v[92:95], a[112:127]
  ds_read_b64_tr_b16 v[190:191], v3 offset:10752
  s_mov_b32 s30, 24576
  buffer_load_dwordx4 v[80:83], v4, s[8:11], s30 offen
  buffer_load_dwordx4 v[84:87], v5, s[8:11], s30 offen
  buffer_load_dwordx4 v[88:91], v6, s[8:11], s30 offen
  buffer_load_dwordx4 v[92:95], v7, s[8:11], s30 offen
  s_waitcnt lgkmcnt(10)
  v_mfma_f32_32x32x16_bf16 a[0:15], v[200:203], v[96:99], a[0:15]
  s_waitcnt lgkmcnt(8)
  v_mfma_f32_32x32x16_bf16 a[16:31], v[204:207], v[96:99], a[16:31]
  v_mfma_f32_32x32x16_bf16 a[32:47], v[200:203], v[100:103], a[32:47]
  v_mfma_f32_32x32x16_bf16 a[48:63], v[204:207], v[100:103], a[48:63]
  v_mfma_f32_32x32x16_bf16 a[64:79], v[200:203], v[104:107], a[64:79]
  v_mfma_f32_32x32x16_bf16 a[80:95], v[204:207], v[104:107], a[80:95]
  v_mfma_f32_32x32x16_bf16 a[96:111], v[200:203], v[108:111], a[96:111]
  v_mfma_f32_32x32x16_bf16 a[112:127], v[204:207], v[108:111], a[112:127]
  s_mov_b32 s30, 25600
  buffer_load_dwordx4 v[96:99], v4, s[8:11], s30 offen
  buffer_load_dwordx4 v[100:103], v5, s[8:11], s30 offen
  buffer_load_dwordx4 v[104:107], v6, s[8:11], s30 offen
  buffer_load_dwordx4 v[108:111], v7, s[8:11], s30 offen
  s_add_u32 m0, s33, 4096
  s_mov_b32 s32, 425984
  buffer_load_dwordx4 v8, s[12:15], s32 offen lds
  s_add_u32 m0, s33, 5120
  s_mov_b32 s32, 434176
  buffer_load_dwordx4 v8, s[12:15], s32 offen lds
  s_add_u32 m0, s33, 6144
  s_mov_b32 s32, 442368
  buffer_load_dwordx4 v8, s[12:15], s32 offen lds
  s_add_u32 m0, s33, 7168
  s_mov_b32 s32, 450560
  buffer_load_dwordx4 v8, s[12:15], s32 offen lds
  s_waitcnt vmcnt(48)
  s_waitcnt lgkmcnt(6)
  v_mfma_f32_32x32x16_bf16 a[0:15], v[176:179], v[112:115], a[0:15]
  ds_read_b64_tr_b16 v[192:193], v2 offset:12288
  s_waitcnt lgkmcnt(5)
  v_mfma_f32_32x32x16_bf16 a[16:31], v[180:183], v[112:115], a[16:31]
  ds_read_b64_tr_b16 v[194:195], v2 offset:12800
  v_mfma_f32_32x32x16_bf16 a[32:47], v[176:179], v[116:119], a[32:47]
  ds_read_b64_tr_b16 v[196:197], v3 offset:12288
  v_mfma_f32_32x32x16_bf16 a[48:63], v[180:183], v[116:119], a[48:63]
  ds_read_b64_tr_b16 v[198:199], v3 offset:12800
  v_mfma_f32_32x32x16_bf16 a[64:79], v[176:179], v[120:123], a[64:79]
  ds_read_b64_tr_b16 v[200:201], v2 offset:14336
  v_mfma_f32_32x32x16_bf16 a[80:95], v[180:183], v[120:123], a[80:95]
  ds_read_b64_tr_b16 v[202:203], v2 offset:14848
  v_mfma_f32_32x32x16_bf16 a[96:111], v[176:179], v[124:127], a[96:111]
  ds_read_b64_tr_b16 v[204:205], v3 offset:14336
  v_mfma_f32_32x32x16_bf16 a[112:127], v[180:183], v[124:127], a[112:127]
  ds_read_b64_tr_b16 v[206:207], v3 offset:14848
  s_mov_b32 s30, 26624
  buffer_load_dwordx4 v[112:115], v4, s[8:11], s30 offen
  buffer_load_dwordx4 v[116:119], v5, s[8:11], s30 offen
  buffer_load_dwordx4 v[120:123], v6, s[8:11], s30 offen
  buffer_load_dwordx4 v[124:127], v7, s[8:11], s30 offen
  s_waitcnt lgkmcnt(10)
  v_mfma_f32_32x32x16_bf16 a[0:15], v[184:187], v[128:131], a[0:15]
  s_waitcnt lgkmcnt(8)
  v_mfma_f32_32x32x16_bf16 a[16:31], v[188:191], v[128:131], a[16:31]
  v_mfma_f32_32x32x16_bf16 a[32:47], v[184:187], v[132:135], a[32:47]
  v_mfma_f32_32x32x16_bf16 a[48:63], v[188:191], v[132:135], a[48:63]
  v_mfma_f32_32x32x16_bf16 a[64:79], v[184:187], v[136:139], a[64:79]
  v_mfma_f32_32x32x16_bf16 a[80:95], v[188:191], v[136:139], a[80:95]
  v_mfma_f32_32x32x16_bf16 a[96:111], v[184:187], v[140:143], a[96:111]
  v_mfma_f32_32x32x16_bf16 a[112:127], v[188:191], v[140:143], a[112:127]
  s_mov_b32 s30, 27648
  buffer_load_dwordx4 v[128:131], v4, s[8:11], s30 offen
  buffer_load_dwordx4 v[132:135], v5, s[8:11], s30 offen
  buffer_load_dwordx4 v[136:139], v6, s[8:11], s30 offen
  buffer_load_dwordx4 v[140:143], v7, s[8:11], s30 offen
  s_add_u32 m0, s33, 8192
  s_mov_b32 s32, 458752
  buffer_load_dwordx4 v8, s[12:15], s32 offen lds
  s_add_u32 m0, s33, 9216
  s_mov_b32 s32, 466944
  buffer_load_dwordx4 v8, s[12:15], s32 offen lds
  s_add_u32 m0, s33, 10240
  s_mov_b32 s32, 475136
  buffer_load_dwordx4 v8, s[12:15], s32 offen lds
  s_add_u32 m0, s33, 11264
  s_mov_b32 s32, 483328
  buffer_load_dwordx4 v8, s[12:15], s32 offen lds
  s_waitcnt vmcnt(48)
  s_waitcnt lgkmcnt(6)
  v_mfma_f32_32x32x16_bf16 a[0:15], v[192:195], v[144:147], a[0:15]
  ds_read_b64_tr_b16 v[176:177], v2 offset:16384
  s_waitcnt lgkmcnt(5)
  v_mfma_f32_32x32x16_bf16 a[16:31], v[196:199], v[144:147], a[16:31]
  ds_read_b64_tr_b16 v[178:179], v2 offset:16896
  v_mfma_f32_32x32x16_bf16 a[32:47], v[192:195], v[148:151], a[32:47]
  ds_read_b64_tr_b16 v[180:181], v3 offset:16384
  v_mfma_f32_32x32x16_bf16 a[48:63], v[196:199], v[148:151], a[48:63]
  ds_read_b64_tr_b16 v[182:183], v3 offset:16896
  v_mfma_f32_32x32x16_bf16 a[64:79], v[192:195], v[152:155], a[64:79]
  ds_read_b64_tr_b16 v[184:185], v2 offset:18432
  v_mfma_f32_32x32x16_bf16 a[80:95], v[196:199], v[152:155], a[80:95]
  ds_read_b64_tr_b16 v[186:187], v2 offset:18944
  v_mfma_f32_32x32x16_bf16 a[96:111], v[192:195], v[156:159], a[96:111]
  ds_read_b64_tr_b16 v[188:189], v3 offset:18432
  v_mfma_f32_32x32x16_bf16 a[112:127], v[196:199], v[156:159], a[112:127]
  ds_read_b64_tr_b16 v[190:191], v3 offset:18944
  s_mov_b32 s30, 28672
  buffer_load_dwordx4 v[144:147], v4, s[8:11], s30 offen
  buffer_load_dwordx4 v[148:151], v5, s[8:11], s30 offen
  buffer_load_dwordx4 v[152:155], v6, s[8:11], s30 offen
  buffer_load_dwordx4 v[156:159], v7, s[8:11], s30 offen
  s_waitcnt lgkmcnt(10)
  v_mfma_f32_32x32x16_bf16 a[0:15], v[200:203], v[160:163], a[0:15]
  s_waitcnt lgkmcnt(8)
  v_mfma_f32_32x32x16_bf16 a[16:31], v[204:207], v[160:163], a[16:31]
  v_mfma_f32_32x32x16_bf16 a[32:47], v[200:203], v[164:167], a[32:47]
  v_mfma_f32_32x32x16_bf16 a[48:63], v[204:207], v[164:167], a[48:63]
  v_mfma_f32_32x32x16_bf16 a[64:79], v[200:203], v[168:171], a[64:79]
  v_mfma_f32_32x32x16_bf16 a[80:95], v[204:207], v[168:171], a[80:95]
  v_mfma_f32_32x32x16_bf16 a[96:111], v[200:203], v[172:175], a[96:111]
  v_mfma_f32_32x32x16_bf16 a[112:127], v[204:207], v[172:175], a[112:127]
  s_mov_b32 s30, 29696
  buffer_load_dwordx4 v[160:163], v4, s[8:11], s30 offen
  buffer_load_dwordx4 v[164:167], v5, s[8:11], s30 offen
  buffer_load_dwordx4 v[168:171], v6, s[8:11], s30 offen
  buffer_load_dwordx4 v[172:175], v7, s[8:11], s30 offen
  s_add_u32 m0, s33, 12288
  s_mov_b32 s32, 491520
  buffer_load_dwordx4 v8, s[12:15], s32 offen lds
  s_add_u32 m0, s33, 13312
  s_mov_b32 s32, 499712
  buffer_load_dwordx4 v8, s[12:15], s32 offen lds
  s_add_u32 m0, s33, 14336
  s_mov_b32 s32, 507904
  buffer_load_dwordx4 v8, s[12:15], s32 offen lds
  s_add_u32 m0, s33, 15360
  s_mov_b32 s32, 516096
  buffer_load_dwordx4 v8, s[12:15], s32 offen lds
  s_waitcnt vmcnt(48)
  s_waitcnt lgkmcnt(6)
  v_mfma_f32_32x32x16_bf16 a[0:15], v[176:179], v[16:19], a[0:15]
  ds_read_b64_tr_b16 v[192:193], v2 offset:20480
  s_waitcnt lgkmcnt(5)
  v_mfma_f32_32x32x16_bf16 a[16:31], v[180:183], v[16:19], a[16:31]
  ds_read_b64_tr_b16 v[194:195], v2 offset:20992
  v_mfma_f32_32x32x16_bf16 a[32:47], v[176:179], v[20:23], a[32:47]
  ds_read_b64_tr_b16 v[196:197], v3 offset:20480
  v_mfma_f32_32x32x16_bf16 a[48:63], v[180:183], v[20:23], a[48:63]
  ds_read_b64_tr_b16 v[198:199], v3 offset:20992
  v_mfma_f32_32x32x16_bf16 a[64:79], v[176:179], v[24:27], a[64:79]
  ds_read_b64_tr_b16 v[200:201], v2 offset:22528
  v_mfma_f32_32x32x16_bf16 a[80:95], v[180:183], v[24:27], a[80:95]
  ds_read_b64_tr_b16 v[202:203], v2 offset:23040
  v_mfma_f32_32x32x16_bf16 a[96:111], v[176:179], v[28:31], a[96:111]
  ds_read_b64_tr_b16 v[204:205], v3 offset:22528
  v_mfma_f32_32x32x16_bf16 a[112:127], v[180:183], v[28:31], a[112:127]
  ds_read_b64_tr_b16 v[206:207], v3 offset:23040
  s_mov_b32 s30, 30720
  buffer_load_dwordx4 v[16:19], v4, s[8:11], s30 offen
  buffer_load_dwordx4 v[20:23], v5, s[8:11], s30 offen
  buffer_load_dwordx4 v[24:27], v6, s[8:11], s30 offen
  buffer_load_dwordx4 v[28:31], v7, s[8:11], s30 offen
  s_waitcnt lgkmcnt(10)
  v_mfma_f32_32x32x16_bf16 a[0:15], v[184:187], v[32:35], a[0:15]
  s_waitcnt lgkmcnt(8)
  v_mfma_f32_32x32x16_bf16 a[16:31], v[188:191], v[32:35], a[16:31]
  v_mfma_f32_32x32x16_bf16 a[32:47], v[184:187], v[36:39], a[32:47]
  v_mfma_f32_32x32x16_bf16 a[48:63], v[188:191], v[36:39], a[48:63]
  v_mfma_f32_32x32x16_bf16 a[64:79], v[184:187], v[40:43], a[64:79]
  v_mfma_f32_32x32x16_bf16 a[80:95], v[188:191], v[40:43], a[80:95]
  v_mfma_f32_32x32x16_bf16 a[96:111], v[184:187], v[44:47], a[96:111]
  v_mfma_f32_32x32x16_bf16 a[112:127], v[188:191], v[44:47], a[112:127]
  s_mov_b32 s30, 31744
  buffer_load_dwordx4 v[32:35], v4, s[8:11], s30 offen
  buffer_load_dwordx4 v[36:39], v5, s[8:11], s30 offen
  buffer_load_dwordx4 v[40:43], v6, s[8:11], s30 offen
  buffer_load_dwordx4 v[44:47], v7, s[8:11], s30 offen
  s_add_u32 m0, s33, 16384
  s_mov_b32 s32, 524288
  buffer_load_dwordx4 v8, s[12:15], s32 offen lds
  s_add_u32 m0, s33, 17408
  s_mov_b32 s32, 532480
  buffer_load_dwordx4 v8, s[12:15], s32 offen lds
  s_add_u32 m0, s33, 18432
  s_mov_b32 s32, 540672
  buffer_load_dwordx4 v8, s[12:15], s32 offen lds
  s_add_u32 m0, s33, 19456
  s_mov_b32 s32, 548864
  buffer_load_dwordx4 v8, s[12:15], s32 offen lds
  s_waitcnt vmcnt(48)
  s_waitcnt lgkmcnt(6)
  v_mfma_f32_32x32x16_bf16 a[0:15], v[192:195], v[48:51], a[0:15]
  ds_read_b64_tr_b16 v[176:177], v2 offset:0
  s_waitcnt lgkmcnt(5)
  v_mfma_f32_32x32x16_bf16 a[16:31], v[196:199], v[48:51], a[16:31]
  ds_read_b64_tr_b16 v[178:179], v2 offset:512
  v_mfma_f32_32x32x16_bf16 a[32:47], v[192:195], v[52:55], a[32:47]
  ds_read_b64_tr_b16 v[180:181], v3 offset:0
  v_mfma_f32_32x32x16_bf16 a[48:63], v[196:199], v[52:55], a[48:63]
  ds_read_b64_tr_b16 v[182:183], v3 offset:512
  v_mfma_f32_32x32x16_bf16 a[64:79], v[192:195], v[56:59], a[64:79]
  ds_read_b64_tr_b16 v[184:185], v2 offset:2048
  v_mfma_f32_32x32x16_bf16 a[80:95], v[196:199], v[56:59], a[80:95]
  ds_read_b64_tr_b16 v[186:187], v2 offset:2560
  v_mfma_f32_32x32x16_bf16 a[96:111], v[192:195], v[60:63], a[96:111]
  ds_read_b64_tr_b16 v[188:189], v3 offset:2048
  v_mfma_f32_32x32x16_bf16 a[112:127], v[196:199], v[60:63], a[112:127]
  ds_read_b64_tr_b16 v[190:191], v3 offset:2560
  s_mov_b32 s30, 32768
  buffer_load_dwordx4 v[48:51], v4, s[8:11], s30 offen
  buffer_load_dwordx4 v[52:55], v5, s[8:11], s30 offen
  buffer_load_dwordx4 v[56:59], v6, s[8:11], s30 offen
  buffer_load_dwordx4 v[60:63], v7, s[8:11], s30 offen
  s_waitcnt lgkmcnt(10)
  v_mfma_f32_32x32x16_bf16 a[0:15], v[200:203], v[64:67], a[0:15]
  s_waitcnt lgkmcnt(8)
  v_mfma_f32_32x32x16_bf16 a[16:31], v[204:207], v[64:67], a[16:31]
  v_mfma_f32_32x32x16_bf16 a[32:47], v[200:203], v[68:71], a[32:47]
  v_mfma_f32_32x32x16_bf16 a[48:63], v[204:207], v[68:71], a[48:63]
  v_mfma_f32_32x32x16_bf16 a[64:79], v[200:203], v[72:75], a[64:79]
  v_mfma_f32_32x32x16_bf16 a[80:95], v[204:207], v[72:75], a[80:95]
  v_mfma_f32_32x32x16_bf16 a[96:111], v[200:203], v[76:79], a[96:111]
  v_mfma_f32_32x32x16_bf16 a[112:127], v[204:207], v[76:79], a[112:127]
  s_mov_b32 s30, 33792
  buffer_load_dwordx4 v[64:67], v4, s[8:11], s30 offen
  buffer_load_dwordx4 v[68:71], v5, s[8:11], s30 offen
  buffer_load_dwordx4 v[72:75], v6, s[8:11], s30 offen
  buffer_load_dwordx4 v[76:79], v7, s[8:11], s30 offen
  s_add_u32 m0, s33, 20480
  s_mov_b32 s32, 557056
  buffer_load_dwordx4 v8, s[12:15], s32 offen lds
  s_add_u32 m0, s33, 21504
  s_mov_b32 s32, 565248
  buffer_load_dwordx4 v8, s[12:15], s32 offen lds
  s_add_u32 m0, s33, 22528
  s_mov_b32 s32, 573440
  buffer_load_dwordx4 v8, s[12:15], s32 offen lds
  s_add_u32 m0, s33, 23552
  s_mov_b32 s32, 581632
  buffer_load_dwordx4 v8, s[12:15], s32 offen lds
  s_waitcnt vmcnt(48)
  s_waitcnt lgkmcnt(6)
  v_mfma_f32_32x32x16_bf16 a[0:15], v[176:179], v[80:83], a[0:15]
  ds_read_b64_tr_b16 v[192:193], v2 offset:4096
  s_waitcnt lgkmcnt(5)
  v_mfma_f32_32x32x16_bf16 a[16:31], v[180:183], v[80:83], a[16:31]
  ds_read_b64_tr_b16 v[194:195], v2 offset:4608
  v_mfma_f32_32x32x16_bf16 a[32:47], v[176:179], v[84:87], a[32:47]
  ds_read_b64_tr_b16 v[196:197], v3 offset:4096
  v_mfma_f32_32x32x16_bf16 a[48:63], v[180:183], v[84:87], a[48:63]
  ds_read_b64_tr_b16 v[198:199], v3 offset:4608
  v_mfma_f32_32x32x16_bf16 a[64:79], v[176:179], v[88:91], a[64:79]
  ds_read_b64_tr_b16 v[200:201], v2 offset:6144
  v_mfma_f32_32x32x16_bf16 a[80:95], v[180:183], v[88:91], a[80:95]
  ds_read_b64_tr_b16 v[202:203], v2 offset:6656
  v_mfma_f32_32x32x16_bf16 a[96:111], v[176:179], v[92:95], a[96:111]
  ds_read_b64_tr_b16 v[204:205], v3 offset:6144
  v_mfma_f32_32x32x16_bf16 a[112:127], v[180:183], v[92:95], a[112:127]
  ds_read_b64_tr_b16 v[206:207], v3 offset:6656
  s_mov_b32 s30, 34816
  buffer_load_dwordx4 v[80:83], v4, s[8:11], s30 offen
  buffer_load_dwordx4 v[84:87], v5, s[8:11], s30 offen
  buffer_load_dwordx4 v[88:91], v6, s[8:11], s30 offen
  buffer_load_dwordx4 v[92:95], v7, s[8:11], s30 offen
  s_waitcnt lgkmcnt(10)
  v_mfma_f32_32x32x16_bf16 a[0:15], v[184:187], v[96:99], a[0:15]
  s_waitcnt lgkmcnt(8)
  v_mfma_f32_32x32x16_bf16 a[16:31], v[188:191], v[96:99], a[16:31]
  v_mfma_f32_32x32x16_bf16 a[32:47], v[184:187], v[100:103], a[32:47]
  v_mfma_f32_32x32x16_bf16 a[48:63], v[188:191], v[100:103], a[48:63]
  v_mfma_f32_32x32x16_bf16 a[64:79], v[184:187], v[104:107], a[64:79]
  v_mfma_f32_32x32x16_bf16 a[80:95], v[188:191], v[104:107], a[80:95]
  v_mfma_f32_32x32x16_bf16 a[96:111], v[184:187], v[108:111], a[96:111]
  v_mfma_f32_32x32x16_bf16 a[112:127], v[188:191], v[108:111], a[112:127]
  s_mov_b32 s30, 35840
  buffer_load_dwordx4 v[96:99], v4, s[8:11], s30 offen
  buffer_load_dwordx4 v[100:103], v5, s[8:11], s30 offen
  buffer_load_dwordx4 v[104:107], v6, s[8:11], s30 offen
  buffer_load_dwordx4 v[108:111], v7, s[8:11], s30 offen
  s_add_u32 m0, s33, 0
  s_mov_b32 s32, 589824
  buffer_load_dwordx4 v8, s[12:15], s32 offen lds
  s_add_u32 m0, s33, 1024
  s_mov_b32 s32, 598016
  buffer_load_dwordx4 v8, s[12:15], s32 offen lds
  s_add_u32 m0, s33, 2048
  s_mov_b32 s32, 606208
  buffer_load_dwordx4 v8, s[12:15], s32 offen lds
  s_add_u32 m0, s33, 3072
  s_mov_b32 s32, 614400
  buffer_load_dwordx4 v8, s[12:15], s32 offen lds
  s_waitcnt vmcnt(48)
  s_waitcnt lgkmcnt(6)
  v_mfma_f32_32x32x16_bf16 a[0:15], v[192:195], v[112:115], a[0:15]
  ds_read_b64_tr_b16 v[176:177], v2 offset:8192
  s_waitcnt lgkmcnt(5)
  v_mfma_f32_32x32x16_bf16 a[16:31], v[196:199], v[112:115], a[16:31]
  ds_read_b64_tr_b16 v[178:179], v2 offset:8704
  v_mfma_f32_32x32x16_bf16 a[32:47], v[192:195], v[116:119], a[32:47]
  ds_read_b64_tr_b16 v[180:181], v3 offset:8192
  v_mfma_f32_32x32x16_bf16 a[48:63], v[196:199], v[116:119], a[48:63]
  ds_read_b64_tr_b16 v[182:183], v3 offset:8704
  v_mfma_f32_32x32x16_bf16 a[64:79], v[192:195], v[120:123], a[64:79]
  ds_read_b64_tr_b16 v[184:185], v2 offset:10240
  v_mfma_f32_32x32x16_bf16 a[80:95], v[196:199], v[120:123], a[80:95]
  ds_read_b64_tr_b16 v[186:187], v2 offset:10752
  v_mfma_f32_32x32x16_bf16 a[96:111], v[192:195], v[124:127], a[96:111]
  ds_read_b64_tr_b16 v[188:189], v3 offset:10240
  v_mfma_f32_32x32x16_bf16 a[112:127], v[196:199], v[124:127], a[112:127]
  ds_read_b64_tr_b16 v[190:191], v3 offset:10752
  s_mov_b32 s30, 36864
  buffer_load_dwordx4 v[112:115], v4, s[8:11], s30 offen
  buffer_load_dwordx4 v[116:119], v5, s[8:11], s30 offen
  buffer_load_dwordx4 v[120:123], v6, s[8:11], s30 offen
  buffer_load_dwordx4 v[124:127], v7, s[8:11], s30 offen
  s_waitcnt lgkmcnt(10)
  v_mfma_f32_32x32x16_bf16 a[0:15], v[200:203], v[128:131], a[0:15]
  s_waitcnt lgkmcnt(8)
  v_mfma_f32_32x32x16_bf16 a[16:31], v[204:207], v[128:131], a[16:31]
  v_mfma_f32_32x32x16_bf16 a[32:47], v[200:203], v[132:135], a[32:47]
  v_mfma_f32_32x32x16_bf16 a[48:63], v[204:207], v[132:135], a[48:63]
  v_mfma_f32_32x32x16_bf16 a[64:79], v[200:203], v[136:139], a[64:79]
  v_mfma_f32_32x32x16_bf16 a[80:95], v[204:207], v[136:139], a[80:95]
  v_mfma_f32_32x32x16_bf16 a[96:111], v[200:203], v[140:143], a[96:111]
  v_mfma_f32_32x32x16_bf16 a[112:127], v[204:207], v[140:143], a[112:127]
  s_mov_b32 s30, 37888
  buffer_load_dwordx4 v[128:131], v4, s[8:11], s30 offen
  buffer_load_dwordx4 v[132:135], v5, s[8:11], s30 offen
  buffer_load_dwordx4 v[136:139], v6, s[8:11], s30 offen
  buffer_load_dwordx4 v[140:143], v7, s[8:11], s30 offen
  s_add_u32 m0, s33, 4096
  s_mov_b32 s32, 622592
  buffer_load_dwordx4 v8, s[12:15], s32 offen lds
  s_add_u32 m0, s33, 5120
  s_mov_b32 s32, 630784
  buffer_load_dwordx4 v8, s[12:15], s32 offen lds
  s_add_u32 m0, s33, 6144
  s_mov_b32 s32, 638976
  buffer_load_dwordx4 v8, s[12:15], s32 offen lds
  s_add_u32 m0, s33, 7168
  s_mov_b32 s32, 647168
  buffer_load_dwordx4 v8, s[12:15], s32 offen lds
  s_waitcnt vmcnt(48)
  s_waitcnt lgkmcnt(6)
  v_mfma_f32_32x32x16_bf16 a[0:15], v[176:179], v[144:147], a[0:15]
  ds_read_b64_tr_b16 v[192:193], v2 offset:12288
  s_waitcnt lgkmcnt(5)
  v_mfma_f32_32x32x16_bf16 a[16:31], v[180:183], v[144:147], a[16:31]
  ds_read_b64_tr_b16 v[194:195], v2 offset:12800
  v_mfma_f32_32x32x16_bf16 a[32:47], v[176:179], v[148:151], a[32:47]
  ds_read_b64_tr_b16 v[196:197], v3 offset:12288
  v_mfma_f32_32x32x16_bf16 a[48:63], v[180:183], v[148:151], a[48:63]
  ds_read_b64_tr_b16 v[198:199], v3 offset:12800
  v_mfma_f32_32x32x16_bf16 a[64:79], v[176:179], v[152:155], a[64:79]
  ds_read_b64_tr_b16 v[200:201], v2 offset:14336
  v_mfma_f32_32x32x16_bf16 a[80:95], v[180:183], v[152:155], a[80:95]
  ds_read_b64_tr_b16 v[202:203], v2 offset:14848
  v_mfma_f32_32x32x16_bf16 a[96:111], v[176:179], v[156:159], a[96:111]
  ds_read_b64_tr_b16 v[204:205], v3 offset:14336
  v_mfma_f32_32x32x16_bf16 a[112:127], v[180:183], v[156:159], a[112:127]
  ds_read_b64_tr_b16 v[206:207], v3 offset:14848
  s_mov_b32 s30, 38912
  buffer_load_dwordx4 v[144:147], v4, s[8:11], s30 offen
  buffer_load_dwordx4 v[148:151], v5, s[8:11], s30 offen
  buffer_load_dwordx4 v[152:155], v6, s[8:11], s30 offen
  buffer_load_dwordx4 v[156:159], v7, s[8:11], s30 offen
  s_waitcnt lgkmcnt(10)
  v_mfma_f32_32x32x16_bf16 a[0:15], v[184:187], v[160:163], a[0:15]
  s_waitcnt lgkmcnt(8)
  v_mfma_f32_32x32x16_bf16 a[16:31], v[188:191], v[160:163], a[16:31]
  v_mfma_f32_32x32x16_bf16 a[32:47], v[184:187], v[164:167], a[32:47]
  v_mfma_f32_32x32x16_bf16 a[48:63], v[188:191], v[164:167], a[48:63]
  v_mfma_f32_32x32x16_bf16 a[64:79], v[184:187], v[168:171], a[64:79]
  v_mfma_f32_32x32x16_bf16 a[80:95], v[188:191], v[168:171], a[80:95]
  v_mfma_f32_32x32x16_bf16 a[96:111], v[184:187], v[172:175], a[96:111]
  v_mfma_f32_32x32x16_bf16 a[112:127], v[188:191], v[172:175], a[112:127]
  s_mov_b32 s30, 39936
  buffer_load_dwordx4 v[160:163], v4, s[8:11], s30 offen
  buffer_load_dwordx4 v[164:167], v5, s[8:11], s30 offen
  buffer_load_dwordx4 v[168:171], v6, s[8:11], s30 offen
  buffer_load_dwordx4 v[172:175], v7, s[8:11], s30 offen
  s_add_u32 m0, s33, 8192
  s_mov_b32 s32, 655360
  buffer_load_dwordx4 v8, s[12:15], s32 offen lds
  s_add_u32 m0, s33, 9216
  s_mov_b32 s32, 663552
  buffer_load_dwordx4 v8, s[12:15], s32 offen lds
  s_add_u32 m0, s33, 10240
  s_mov_b32 s32, 671744
  buffer_load_dwordx4 v8, s[12:15], s32 offen lds
  s_add_u32 m0, s33, 11264
  s_mov_b32 s32, 679936
  buffer_load_dwordx4 v8, s[12:15], s32 offen lds
  s_waitcnt vmcnt(48)
  s_waitcnt lgkmcnt(6)
  v_mfma_f32_32x32x16_bf16 a[0:15], v[192:195], v[16:19], a[0:15]
  ds_read_b64_tr_b16 v[176:177], v2 offset:16384
  s_waitcnt lgkmcnt(5)
  v_mfma_f32_32x32x16_bf16 a[16:31], v[196:199], v[16:19], a[16:31]
  ds_read_b64_tr_b16 v[178:179], v2 offset:16896
  v_mfma_f32_32x32x16_bf16 a[32:47], v[192:195], v[20:23], a[32:47]
  ds_read_b64_tr_b16 v[180:181], v3 offset:16384
  v_mfma_f32_32x32x16_bf16 a[48:63], v[196:199], v[20:23], a[48:63]
  ds_read_b64_tr_b16 v[182:183], v3 offset:16896
  v_mfma_f32_32x32x16_bf16 a[64:79], v[192:195], v[24:27], a[64:79]
  ds_read_b64_tr_b16 v[184:185], v2 offset:18432
  v_mfma_f32_32x32x16_bf16 a[80:95], v[196:199], v[24:27], a[80:95]
  ds_read_b64_tr_b16 v[186:187], v2 offset:18944
  v_mfma_f32_32x32x16_bf16 a[96:111], v[192:195], v[28:31], a[96:111]
  ds_read_b64_tr_b16 v[188:189], v3 offset:18432
  v_mfma_f32_32x32x16_bf16 a[112:127], v[196:199], v[28:31], a[112:127]
  ds_read_b64_tr_b16 v[190:191], v3 offset:18944
  s_mov_b32 s30, 40960
  buffer_load_dwordx4 v[16:19], v4, s[8:11], s30 offen
  buffer_load_dwordx4 v[20:23], v5, s[8:11], s30 offen
  buffer_load_dwordx4 v[24:27], v6, s[8:11], s30 offen
  buffer_load_dwordx4 v[28:31], v7, s[8:11], s30 offen
  s_waitcnt lgkmcnt(10)
  v_mfma_f32_32x32x16_bf16 a[0:15], v[200:203], v[32:35], a[0:15]
  s_waitcnt lgkmcnt(8)
  v_mfma_f32_32x32x16_bf16 a[16:31], v[204:207], v[32:35], a[16:31]
  v_mfma_f32_32x32x16_bf16 a[32:47], v[200:203], v[36:39], a[32:47]
  v_mfma_f32_32x32x16_bf16 a[48:63], v[204:207], v[36:39], a[48:63]
  v_mfma_f32_32x32x16_bf16 a[64:79], v[200:203], v[40:43], a[64:79]
  v_mfma_f32_32x32x16_bf16 a[80:95], v[204:207], v[40:43], a[80:95]
  v_mfma_f32_32x32x16_bf16 a[96:111], v[200:203], v[44:47], a[96:111]
  v_mfma_f32_32x32x16_bf16 a[112:127], v[204:207], v[44:47], a[112:127]
  s_mov_b32 s30, 41984
  buffer_load_dwordx4 v[32:35], v4, s[8:11], s30 offen
  buffer_load_dwordx4 v[36:39], v5, s[8:11], s30 offen
  buffer_load_dwordx4 v[40:43], v6, s[8:11], s30 offen
  buffer_load_dwordx4 v[44:47], v7, s[8:11], s30 offen
  s_add_u32 m0, s33, 12288
  s_mov_b32 s32, 688128
  buffer_load_dwordx4 v8, s[12:15], s32 offen lds
  s_add_u32 m0, s33, 13312
  s_mov_b32 s32, 696320
  buffer_load_dwordx4 v8, s[12:15], s32 offen lds
  s_add_u32 m0, s33, 14336
  s_mov_b32 s32, 704512
  buffer_load_dwordx4 v8, s[12:15], s32 offen lds
  s_add_u32 m0, s33, 15360
  s_mov_b32 s32, 712704
  buffer_load_dwordx4 v8, s[12:15], s32 offen lds
  s_waitcnt vmcnt(48)
  s_waitcnt lgkmcnt(6)
  v_mfma_f32_32x32x16_bf16 a[0:15], v[176:179], v[48:51], a[0:15]
  ds_read_b64_tr_b16 v[192:193], v2 offset:20480
  s_waitcnt lgkmcnt(5)
  v_mfma_f32_32x32x16_bf16 a[16:31], v[180:183], v[48:51], a[16:31]
  ds_read_b64_tr_b16 v[194:195], v2 offset:20992
  v_mfma_f32_32x32x16_bf16 a[32:47], v[176:179], v[52:55], a[32:47]
  ds_read_b64_tr_b16 v[196:197], v3 offset:20480
  v_mfma_f32_32x32x16_bf16 a[48:63], v[180:183], v[52:55], a[48:63]
  ds_read_b64_tr_b16 v[198:199], v3 offset:20992
  v_mfma_f32_32x32x16_bf16 a[64:79], v[176:179], v[56:59], a[64:79]
  ds_read_b64_tr_b16 v[200:201], v2 offset:22528
  v_mfma_f32_32x32x16_bf16 a[80:95], v[180:183], v[56:59], a[80:95]
  ds_read_b64_tr_b16 v[202:203], v2 offset:23040
  v_mfma_f32_32x32x16_bf16 a[96:111], v[176:179], v[60:63], a[96:111]
  ds_read_b64_tr_b16 v[204:205], v3 offset:22528
  v_mfma_f32_32x32x16_bf16 a[112:127], v[180:183], v[60:63], a[112:127]
  ds_read_b64_tr_b16 v[206:207], v3 offset:23040
  s_mov_b32 s30, 43008
  buffer_load_dwordx4 v[48:51], v4, s[8:11], s30 offen
  buffer_load_dwordx4 v[52:55], v5, s[8:11], s30 offen
  buffer_load_dwordx4 v[56:59], v6, s[8:11], s30 offen
  buffer_load_dwordx4 v[60:63], v7, s[8:11], s30 offen
  s_waitcnt lgkmcnt(10)
  v_mfma_f32_32x32x16_bf16 a[0:15], v[184:187], v[64:67], a[0:15]
  s_waitcnt lgkmcnt(8)
  v_mfma_f32_32x32x16_bf16 a[16:31], v[188:191], v[64:67], a[16:31]
  v_mfma_f32_32x32x16_bf16 a[32:47], v[184:187], v[68:71], a[32:47]
  v_mfma_f32_32x32x16_bf16 a[48:63], v[188:191], v[68:71], a[48:63]
  v_mfma_f32_32x32x16_bf16 a[64:79], v[184:187], v[72:75], a[64:79]
  v_mfma_f32_32x32x16_bf16 a[80:95], v[188:191], v[72:75], a[80:95]
  v_mfma_f32_32x32x16_bf16 a[96:111], v[184:187], v[76:79], a[96:111]
  v_mfma_f32_32x32x16_bf16 a[112:127], v[188:191], v[76:79], a[112:127]
  s_mov_b32 s30, 44032
  buffer_load_dwordx4 v[64:67], v4, s[8:11], s30 offen
  buffer_load_dwordx4 v[68:71], v5, s[8:11], s30 offen
  buffer_load_dwordx4 v[72:75], v6, s[8:11], s30 offen
  buffer_load_dwordx4 v[76:79], v7, s[8:11], s30 offen
  s_add_u32 m0, s33, 16384
  s_mov_b32 s32, 720896
  buffer_load_dwordx4 v8, s[12:15], s32 offen lds
  s_add_u32 m0, s33, 17408
  s_mov_b32 s32, 729088
  buffer_load_dwordx4 v8, s[12:15], s32 offen lds
  s_add_u32 m0, s33, 18432
  s_mov_b32 s32, 737280
  buffer_load_dwordx4 v8, s[12:15], s32 offen lds
  s_add_u32 m0, s33, 19456
  s_mov_b32 s32, 745472
  buffer_load_dwordx4 v8, s[12:15], s32 offen lds
  s_waitcnt vmcnt(48)
  s_waitcnt lgkmcnt(6)
  v_mfma_f32_32x32x16_bf16 a[0:15], v[192:195], v[80:83], a[0:15]
  ds_read_b64_tr_b16 v[176:177], v2 offset:0
  s_waitcnt lgkmcnt(5)
  v_mfma_f32_32x32x16_bf16 a[16:31], v[196:199], v[80:83], a[16:31]
  ds_read_b64_tr_b16 v[178:179], v2 offset:512
  v_mfma_f32_32x32x16_bf16 a[32:47], v[192:195], v[84:87], a[32:47]
  ds_read_b64_tr_b16 v[180:181], v3 offset:0
  v_mfma_f32_32x32x16_bf16 a[48:63], v[196:199], v[84:87], a[48:63]
  ds_read_b64_tr_b16 v[182:183], v3 offset:512
  v_mfma_f32_32x32x16_bf16 a[64:79], v[192:195], v[88:91], a[64:79]
  ds_read_b64_tr_b16 v[184:185], v2 offset:2048
  v_mfma_f32_32x32x16_bf16 a[80:95], v[196:199], v[88:91], a[80:95]
  ds_read_b64_tr_b16 v[186:187], v2 offset:2560
  v_mfma_f32_32x32x16_bf16 a[96:111], v[192:195], v[92:95], a[96:111]
  ds_read_b64_tr_b16 v[188:189], v3 offset:2048
  v_mfma_f32_32x32x16_bf16 a[112:127], v[196:199], v[92:95], a[112:127]
  ds_read_b64_tr_b16 v[190:191], v3 offset:2560
  s_mov_b32 s30, 45056
  buffer_load_dwordx4 v[80:83], v4, s[8:11], s30 offen
  buffer_load_dwordx4 v[84:87], v5, s[8:11], s30 offen
  buffer_load_dwordx4 v[88:91], v6, s[8:11], s30 offen
  buffer_load_dwordx4 v[92:95], v7, s[8:11], s30 offen
  s_waitcnt lgkmcnt(10)
  v_mfma_f32_32x32x16_bf16 a[0:15], v[200:203], v[96:99], a[0:15]
  s_waitcnt lgkmcnt(8)
  v_mfma_f32_32x32x16_bf16 a[16:31], v[204:207], v[96:99], a[16:31]
  v_mfma_f32_32x32x16_bf16 a[32:47], v[200:203], v[100:103], a[32:47]
  v_mfma_f32_32x32x16_bf16 a[48:63], v[204:207], v[100:103], a[48:63]
  v_mfma_f32_32x32x16_bf16 a[64:79], v[200:203], v[104:107], a[64:79]
  v_mfma_f32_32x32x16_bf16 a[80:95], v[204:207], v[104:107], a[80:95]
  v_mfma_f32_32x32x16_bf16 a[96:111], v[200:203], v[108:111], a[96:111]
  v_mfma_f32_32x32x16_bf16 a[112:127], v[204:207], v[108:111], a[112:127]
  s_mov_b32 s30, 46080
  buffer_load_dwordx4 v[96:99], v4, s[8:11], s30 offen
  buffer_load_dwordx4 v[100:103], v5, s[8:11], s30 offen
  buffer_load_dwordx4 v[104:107], v6, s[8:11], s30 offen
  buffer_load_dwordx4 v[108:111], v7, s[8:11], s30 offen
  s_add_u32 m0, s33, 20480
  s_mov_b32 s32, 753664
  buffer_load_dwordx4 v8, s[12:15], s32 offen lds
  s_add_u32 m0, s33, 21504
  s_mov_b32 s32, 761856
  buffer_load_dwordx4 v8, s[12:15], s32 offen lds
  s_add_u32 m0, s33, 22528
  s_mov_b32 s32, 770048
  buffer_load_dwordx4 v8, s[12:15], s32 offen lds
  s_add_u32 m0, s33, 23552
  s_mov_b32 s32, 778240
  buffer_load_dwordx4 v8, s[12:15], s32 offen lds
  s_waitcnt vmcnt(48)
  s_waitcnt lgkmcnt(6)
  v_mfma_f32_32x32x16_bf16 a[0:15], v[176:179], v[112:115], a[0:15]
  ds_read_b64_tr_b16 v[192:193], v2 offset:4096
  s_waitcnt lgkmcnt(5)
  v_mfma_f32_32x32x16_bf16 a[16:31], v[180:183], v[112:115], a[16:31]
  ds_read_b64_tr_b16 v[194:195], v2 offset:4608
  v_mfma_f32_32x32x16_bf16 a[32:47], v[176:179], v[116:119], a[32:47]
  ds_read_b64_tr_b16 v[196:197], v3 offset:4096
  v_mfma_f32_32x32x16_bf16 a[48:63], v[180:183], v[116:119], a[48:63]
  ds_read_b64_tr_b16 v[198:199], v3 offset:4608
  v_mfma_f32_32x32x16_bf16 a[64:79], v[176:179], v[120:123], a[64:79]
  ds_read_b64_tr_b16 v[200:201], v2 offset:6144
  v_mfma_f32_32x32x16_bf16 a[80:95], v[180:183], v[120:123], a[80:95]
  ds_read_b64_tr_b16 v[202:203], v2 offset:6656
  v_mfma_f32_32x32x16_bf16 a[96:111], v[176:179], v[124:127], a[96:111]
  ds_read_b64_tr_b16 v[204:205], v3 offset:6144
  v_mfma_f32_32x32x16_bf16 a[112:127], v[180:183], v[124:127], a[112:127]
  ds_read_b64_tr_b16 v[206:207], v3 offset:6656
  s_mov_b32 s30, 47104
  buffer_load_dwordx4 v[112:115], v4, s[8:11], s30 offen
  buffer_load_dwordx4 v[116:119], v5, s[8:11], s30 offen
  buffer_load_dwordx4 v[120:123], v6, s[8:11], s30 offen
  buffer_load_dwordx4 v[124:127], v7, s[8:11], s30 offen
  s_waitcnt lgkmcnt(10)
  v_mfma_f32_32x32x16_bf16 a[0:15], v[184:187], v[128:131], a[0:15]
  s_waitcnt lgkmcnt(8)
  v_mfma_f32_32x32x16_bf16 a[16:31], v[188:191], v[128:131], a[16:31]
  v_mfma_f32_32x32x16_bf16 a[32:47], v[184:187], v[132:135], a[32:47]
  v_mfma_f32_32x32x16_bf16 a[48:63], v[188:191], v[132:135], a[48:63]
  v_mfma_f32_32x32x16_bf16 a[64:79], v[184:187], v[136:139], a[64:79]
  v_mfma_f32_32x32x16_bf16 a[80:95], v[188:191], v[136:139], a[80:95]
  v_mfma_f32_32x32x16_bf16 a[96:111], v[184:187], v[140:143], a[96:111]
  v_mfma_f32_32x32x16_bf16 a[112:127], v[188:191], v[140:143], a[112:127]
  s_mov_b32 s30, 48128
  buffer_load_dwordx4 v[128:131], v4, s[8:11], s30 offen
  buffer_load_dwordx4 v[132:135], v5, s[8:11], s30 offen
  buffer_load_dwordx4 v[136:139], v6, s[8:11], s30 offen
  buffer_load_dwordx4 v[140:143], v7, s[8:11], s30 offen
  s_add_u32 m0, s33, 0
  s_mov_b32 s32, 786432
  buffer_load_dwordx4 v8, s[12:15], s32 offen lds
  s_add_u32 m0, s33, 1024
  s_mov_b32 s32, 794624
  buffer_load_dwordx4 v8, s[12:15], s32 offen lds
  s_add_u32 m0, s33, 2048
  s_mov_b32 s32, 802816
  buffer_load_dwordx4 v8, s[12:15], s32 offen lds
  s_add_u32 m0, s33, 3072
  s_mov_b32 s32, 811008
  buffer_load_dwordx4 v8, s[12:15], s32 offen lds
  s_waitcnt vmcnt(48)
  s_waitcnt lgkmcnt(6)
  v_mfma_f32_32x32x16_bf16 a[0:15], v[192:195], v[144:147], a[0:15]
  ds_read_b64_tr_b16 v[176:177], v2 offset:8192
  s_waitcnt lgkmcnt(5)
  v_mfma_f32_32x32x16_bf16 a[16:31], v[196:199], v[144:147], a[16:31]
  ds_read_b64_tr_b16 v[178:179], v2 offset:8704
  v_mfma_f32_32x32x16_bf16 a[32:47], v[192:195], v[148:151], a[32:47]
  ds_read_b64_tr_b16 v[180:181], v3 offset:8192
  v_mfma_f32_32x32x16_bf16 a[48:63], v[196:199], v[148:151], a[48:63]
  ds_read_b64_tr_b16 v[182:183], v3 offset:8704
  v_mfma_f32_32x32x16_bf16 a[64:79], v[192:195], v[152:155], a[64:79]
  ds_read_b64_tr_b16 v[184:185], v2 offset:10240
  v_mfma_f32_32x32x16_bf16 a[80:95], v[196:199], v[152:155], a[80:95]
  ds_read_b64_tr_b16 v[186:187], v2 offset:10752
  v_mfma_f32_32x32x16_bf16 a[96:111], v[192:195], v[156:159], a[96:111]
  ds_read_b64_tr_b16 v[188:189], v3 offset:10240
  v_mfma_f32_32x32x16_bf16 a[112:127], v[196:199], v[156:159], a[112:127]
  ds_read_b64_tr_b16 v[190:191], v3 offset:10752
  s_mov_b32 s30, 49152
  buffer_load_dwordx4 v[144:147], v4, s[8:11], s30 offen
  buffer_load_dwordx4 v[148:151], v5, s[8:11], s30 offen
  buffer_load_dwordx4 v[152:155], v6, s[8:11], s30 offen
  buffer_load_dwordx4 v[156:159], v7, s[8:11], s30 offen
  s_waitcnt lgkmcnt(10)
  v_mfma_f32_32x32x16_bf16 a[0:15], v[200:203], v[160:163], a[0:15]
  s_waitcnt lgkmcnt(8)
  v_mfma_f32_32x32x16_bf16 a[16:31], v[204:207], v[160:163], a[16:31]
  v_mfma_f32_32x32x16_bf16 a[32:47], v[200:203], v[164:167], a[32:47]
  v_mfma_f32_32x32x16_bf16 a[48:63], v[204:207], v[164:167], a[48:63]
  v_mfma_f32_32x32x16_bf16 a[64:79], v[200:203], v[168:171], a[64:79]
  v_mfma_f32_32x32x16_bf16 a[80:95], v[204:207], v[168:171], a[80:95]
  v_mfma_f32_32x32x16_bf16 a[96:111], v[200:203], v[172:175], a[96:111]
  v_mfma_f32_32x32x16_bf16 a[112:127], v[204:207], v[172:175], a[112:127]
  s_mov_b32 s30, 50176
  buffer_load_dwordx4 v[160:163], v4, s[8:11], s30 offen
  buffer_load_dwordx4 v[164:167], v5, s[8:11], s30 offen
  buffer_load_dwordx4 v[168:171], v6, s[8:11], s30 offen
  buffer_load_dwordx4 v[172:175], v7, s[8:11], s30 offen
  s_add_u32 m0, s33, 4096
  s_mov_b32 s32, 819200
  buffer_load_dwordx4 v8, s[12:15], s32 offen lds
  s_add_u32 m0, s33, 5120
  s_mov_b32 s32, 827392
  buffer_load_dwordx4 v8, s[12:15], s32 offen lds
  s_add_u32 m0, s33, 6144
  s_mov_b32 s32, 835584
  buffer_load_dwordx4 v8, s[12:15], s32 offen lds
  s_add_u32 m0, s33, 7168
  s_mov_b32 s32, 843776
  buffer_load_dwordx4 v8, s[12:15], s32 offen lds
  s_waitcnt vmcnt(48)
  s_waitcnt lgkmcnt(6)
  v_mfma_f32_32x32x16_bf16 a[0:15], v[176:179], v[16:19], a[0:15]
  ds_read_b64_tr_b16 v[192:193], v2 offset:12288
  s_waitcnt lgkmcnt(5)
  v_mfma_f32_32x32x16_bf16 a[16:31], v[180:183], v[16:19], a[16:31]
  ds_read_b64_tr_b16 v[194:195], v2 offset:12800
  v_mfma_f32_32x32x16_bf16 a[32:47], v[176:179], v[20:23], a[32:47]
  ds_read_b64_tr_b16 v[196:197], v3 offset:12288
  v_mfma_f32_32x32x16_bf16 a[48:63], v[180:183], v[20:23], a[48:63]
  ds_read_b64_tr_b16 v[198:199], v3 offset:12800
  v_mfma_f32_32x32x16_bf16 a[64:79], v[176:179], v[24:27], a[64:79]
  ds_read_b64_tr_b16 v[200:201], v2 offset:14336
  v_mfma_f32_32x32x16_bf16 a[80:95], v[180:183], v[24:27], a[80:95]
  ds_read_b64_tr_b16 v[202:203], v2 offset:14848
  v_mfma_f32_32x32x16_bf16 a[96:111], v[176:179], v[28:31], a[96:111]
  ds_read_b64_tr_b16 v[204:205], v3 offset:14336
  v_mfma_f32_32x32x16_bf16 a[112:127], v[180:183], v[28:31], a[112:127]
  ds_read_b64_tr_b16 v[206:207], v3 offset:14848
  s_mov_b32 s30, 51200
  buffer_load_dwordx4 v[16:19], v4, s[8:11], s30 offen
  buffer_load_dwordx4 v[20:23], v5, s[8:11], s30 offen
  buffer_load_dwordx4 v[24:27], v6, s[8:11], s30 offen
  buffer_load_dwordx4 v[28:31], v7, s[8:11], s30 offen
  s_waitcnt lgkmcnt(10)
  v_mfma_f32_32x32x16_bf16 a[0:15], v[184:187], v[32:35], a[0:15]
  s_waitcnt lgkmcnt(8)
  v_mfma_f32_32x32x16_bf16 a[16:31], v[188:191], v[32:35], a[16:31]
  v_mfma_f32_32x32x16_bf16 a[32:47], v[184:187], v[36:39], a[32:47]
  v_mfma_f32_32x32x16_bf16 a[48:63], v[188:191], v[36:39], a[48:63]
  v_mfma_f32_32x32x16_bf16 a[64:79], v[184:187], v[40:43], a[64:79]
  v_mfma_f32_32x32x16_bf16 a[80:95], v[188:191], v[40:43], a[80:95]
  v_mfma_f32_32x32x16_bf16 a[96:111], v[184:187], v[44:47], a[96:111]
  v_mfma_f32_32x32x16_bf16 a[112:127], v[188:191], v[44:47], a[112:127]
  s_mov_b32 s30, 52224
  buffer_load_dwordx4 v[32:35], v4, s[8:11], s30 offen
  buffer_load_dwordx4 v[36:39], v5, s[8:11], s30 offen
  buffer_load_dwordx4 v[40:43], v6, s[8:11], s30 offen
  buffer_load_dwordx4 v[44:47], v7, s[8:11], s30 offen
  s_add_u32 m0, s33, 8192
  s_mov_b32 s32, 851968
  buffer_load_dwordx4 v8, s[12:15], s32 offen lds
  s_add_u32 m0, s33, 9216
  s_mov_b32 s32, 860160
  buffer_load_dwordx4 v8, s[12:15], s32 offen lds
  s_add_u32 m0, s33, 10240
  s_mov_b32 s32, 868352
  buffer_load_dwordx4 v8, s[12:15], s32 offen lds
  s_add_u32 m0, s33, 11264
  s_mov_b32 s32, 876544
  buffer_load_dwordx4 v8, s[12:15], s32 offen lds
  s_waitcnt vmcnt(48)
  s_waitcnt lgkmcnt(6)
  v_mfma_f32_32x32x16_bf16 a[0:15], v[192:195], v[48:51], a[0:15]
  ds_read_b64_tr_b16 v[176:177], v2 offset:16384
  s_waitcnt lgkmcnt(5)
  v_mfma_f32_32x32x16_bf16 a[16:31], v[196:199], v[48:51], a[16:31]
  ds_read_b64_tr_b16 v[178:179], v2 offset:16896
  v_mfma_f32_32x32x16_bf16 a[32:47], v[192:195], v[52:55], a[32:47]
  ds_read_b64_tr_b16 v[180:181], v3 offset:16384
  v_mfma_f32_32x32x16_bf16 a[48:63], v[196:199], v[52:55], a[48:63]
  ds_read_b64_tr_b16 v[182:183], v3 offset:16896
  v_mfma_f32_32x32x16_bf16 a[64:79], v[192:195], v[56:59], a[64:79]
  ds_read_b64_tr_b16 v[184:185], v2 offset:18432
  v_mfma_f32_32x32x16_bf16 a[80:95], v[196:199], v[56:59], a[80:95]
  ds_read_b64_tr_b16 v[186:187], v2 offset:18944
  v_mfma_f32_32x32x16_bf16 a[96:111], v[192:195], v[60:63], a[96:111]
  ds_read_b64_tr_b16 v[188:189], v3 offset:18432
  v_mfma_f32_32x32x16_bf16 a[112:127], v[196:199], v[60:63], a[112:127]
  ds_read_b64_tr_b16 v[190:191], v3 offset:18944
  s_mov_b32 s30, 53248
  buffer_load_dwordx4 v[48:51], v4, s[8:11], s30 offen
  buffer_load_dwordx4 v[52:55], v5, s[8:11], s30 offen
  buffer_load_dwordx4 v[56:59], v6, s[8:11], s30 offen
  buffer_load_dwordx4 v[60:63], v7, s[8:11], s30 offen
  s_waitcnt lgkmcnt(10)
  v_mfma_f32_32x32x16_bf16 a[0:15], v[200:203], v[64:67], a[0:15]
  s_waitcnt lgkmcnt(8)
  v_mfma_f32_32x32x16_bf16 a[16:31], v[204:207], v[64:67], a[16:31]
  v_mfma_f32_32x32x16_bf16 a[32:47], v[200:203], v[68:71], a[32:47]
  v_mfma_f32_32x32x16_bf16 a[48:63], v[204:207], v[68:71], a[48:63]
  v_mfma_f32_32x32x16_bf16 a[64:79], v[200:203], v[72:75], a[64:79]
  v_mfma_f32_32x32x16_bf16 a[80:95], v[204:207], v[72:75], a[80:95]
  v_mfma_f32_32x32x16_bf16 a[96:111], v[200:203], v[76:79], a[96:111]
  v_mfma_f32_32x32x16_bf16 a[112:127], v[204:207], v[76:79], a[112:127]
  s_mov_b32 s30, 54272
  buffer_load_dwordx4 v[64:67], v4, s[8:11], s30 offen
  buffer_load_dwordx4 v[68:71], v5, s[8:11], s30 offen
  buffer_load_dwordx4 v[72:75], v6, s[8:11], s30 offen
  buffer_load_dwordx4 v[76:79], v7, s[8:11], s30 offen
  s_add_u32 m0, s33, 12288
  s_mov_b32 s32, 884736
  buffer_load_dwordx4 v8, s[12:15], s32 offen lds
  s_add_u32 m0, s33, 13312
  s_mov_b32 s32, 892928
  buffer_load_dwordx4 v8, s[12:15], s32 offen lds
  s_add_u32 m0, s33, 14336
  s_mov_b32 s32, 901120
  buffer_load_dwordx4 v8, s[12:15], s32 offen lds
  s_add_u32 m0, s33, 15360
  s_mov_b32 s32, 909312
  buffer_load_dwordx4 v8, s[12:15], s32 offen lds
  s_waitcnt vmcnt(48)
  s_waitcnt lgkmcnt(6)
  v_mfma_f32_32x32x16_bf16 a[0:15], v[176:179], v[80:83], a[0:15]
  ds_read_b64_tr_b16 v[192:193], v2 offset:20480
  s_waitcnt lgkmcnt(5)
  v_mfma_f32_32x32x16_bf16 a[16:31], v[180:183], v[80:83], a[16:31]
  ds_read_b64_tr_b16 v[194:195], v2 offset:20992
  v_mfma_f32_32x32x16_bf16 a[32:47], v[176:179], v[84:87], a[32:47]
  ds_read_b64_tr_b16 v[196:197], v3 offset:20480
  v_mfma_f32_32x32x16_bf16 a[48:63], v[180:183], v[84:87], a[48:63]
  ds_read_b64_tr_b16 v[198:199], v3 offset:20992
  v_mfma_f32_32x32x16_bf16 a[64:79], v[176:179], v[88:91], a[64:79]
  ds_read_b64_tr_b16 v[200:201], v2 offset:22528
  v_mfma_f32_32x32x16_bf16 a[80:95], v[180:183], v[88:91], a[80:95]
  ds_read_b64_tr_b16 v[202:203], v2 offset:23040
  v_mfma_f32_32x32x16_bf16 a[96:111], v[176:179], v[92:95], a[96:111]
  ds_read_b64_tr_b16 v[204:205], v3 offset:22528
  v_mfma_f32_32x32x16_bf16 a[112:127], v[180:183], v[92:95], a[112:127]
  ds_read_b64_tr_b16 v[206:207], v3 offset:23040
  s_mov_b32 s30, 55296
  buffer_load_dwordx4 v[80:83], v4, s[8:11], s30 offen
  buffer_load_dwordx4 v[84:87], v5, s[8:11], s30 offen
  buffer_load_dwordx4 v[88:91], v6, s[8:11], s30 offen
  buffer_load_dwordx4 v[92:95], v7, s[8:11], s30 offen
  s_waitcnt lgkmcnt(10)
  v_mfma_f32_32x32x16_bf16 a[0:15], v[184:187], v[96:99], a[0:15]
  s_waitcnt lgkmcnt(8)
  v_mfma_f32_32x32x16_bf16 a[16:31], v[188:191], v[96:99], a[16:31]
  v_mfma_f32_32x32x16_bf16 a[32:47], v[184:187], v[100:103], a[32:47]
  v_mfma_f32_32x32x16_bf16 a[48:63], v[188:191], v[100:103], a[48:63]
  v_mfma_f32_32x32x16_bf16 a[64:79], v[184:187], v[104:107], a[64:79]
  v_mfma_f32_32x32x16_bf16 a[80:95], v[188:191], v[104:107], a[80:95]
  v_mfma_f32_32x32x16_bf16 a[96:111], v[184:187], v[108:111], a[96:111]
  v_mfma_f32_32x32x16_bf16 a[112:127], v[188:191], v[108:111], a[112:127]
  s_mov_b32 s30, 56320
  buffer_load_dwordx4 v[96:99], v4, s[8:11], s30 offen
  buffer_load_dwordx4 v[100:103], v5, s[8:11], s30 offen
  buffer_load_dwordx4 v[104:107], v6, s[8:11], s30 offen
  buffer_load_dwordx4 v[108:111], v7, s[8:11], s30 offen
  s_add_u32 m0, s33, 16384
  s_mov_b32 s32, 917504
  buffer_load_dwordx4 v8, s[12:15], s32 offen lds
  s_add_u32 m0, s33, 17408
  s_mov_b32 s32, 925696
  buffer_load_dwordx4 v8, s[12:15], s32 offen lds
  s_add_u32 m0, s33, 18432
  s_mov_b32 s32, 933888
  buffer_load_dwordx4 v8, s[12:15], s32 offen lds
  s_add_u32 m0, s33, 19456
  s_mov_b32 s32, 942080
  buffer_load_dwordx4 v8, s[12:15], s32 offen lds
  s_waitcnt vmcnt(48)
  s_waitcnt lgkmcnt(6)
  v_mfma_f32_32x32x16_bf16 a[0:15], v[192:195], v[112:115], a[0:15]
  ds_read_b64_tr_b16 v[176:177], v2 offset:0
  s_waitcnt lgkmcnt(5)
  v_mfma_f32_32x32x16_bf16 a[16:31], v[196:199], v[112:115], a[16:31]
  ds_read_b64_tr_b16 v[178:179], v2 offset:512
  v_mfma_f32_32x32x16_bf16 a[32:47], v[192:195], v[116:119], a[32:47]
  ds_read_b64_tr_b16 v[180:181], v3 offset:0
  v_mfma_f32_32x32x16_bf16 a[48:63], v[196:199], v[116:119], a[48:63]
  ds_read_b64_tr_b16 v[182:183], v3 offset:512
  v_mfma_f32_32x32x16_bf16 a[64:79], v[192:195], v[120:123], a[64:79]
  ds_read_b64_tr_b16 v[184:185], v2 offset:2048
  v_mfma_f32_32x32x16_bf16 a[80:95], v[196:199], v[120:123], a[80:95]
  ds_read_b64_tr_b16 v[186:187], v2 offset:2560
  v_mfma_f32_32x32x16_bf16 a[96:111], v[192:195], v[124:127], a[96:111]
  ds_read_b64_tr_b16 v[188:189], v3 offset:2048
  v_mfma_f32_32x32x16_bf16 a[112:127], v[196:199], v[124:127], a[112:127]
  ds_read_b64_tr_b16 v[190:191], v3 offset:2560
  s_mov_b32 s30, 57344
  buffer_load_dwordx4 v[112:115], v4, s[8:11], s30 offen
  buffer_load_dwordx4 v[116:119], v5, s[8:11], s30 offen
  buffer_load_dwordx4 v[120:123], v6, s[8:11], s30 offen
  buffer_load_dwordx4 v[124:127], v7, s[8:11], s30 offen
  s_waitcnt lgkmcnt(10)
  v_mfma_f32_32x32x16_bf16 a[0:15], v[200:203], v[128:131], a[0:15]
  s_waitcnt lgkmcnt(8)
  v_mfma_f32_32x32x16_bf16 a[16:31], v[204:207], v[128:131], a[16:31]
  v_mfma_f32_32x32x16_bf16 a[32:47], v[200:203], v[132:135], a[32:47]
  v_mfma_f32_32x32x16_bf16 a[48:63], v[204:207], v[132:135], a[48:63]
  v_mfma_f32_32x32x16_bf16 a[64:79], v[200:203], v[136:139], a[64:79]
  v_mfma_f32_32x32x16_bf16 a[80:95], v[204:207], v[136:139], a[80:95]
  v_mfma_f32_32x32x16_bf16 a[96:111], v[200:203], v[140:143], a[96:111]
  v_mfma_f32_32x32x16_bf16 a[112:127], v[204:207], v[140:143], a[112:127]
  s_mov_b32 s30, 58368
  buffer_load_dwordx4 v[128:131], v4, s[8:11], s30 offen
  buffer_load_dwordx4 v[132:135], v5, s[8:11], s30 offen
  buffer_load_dwordx4 v[136:139], v6, s[8:11], s30 offen
  buffer_load_dwordx4 v[140:143], v7, s[8:11], s30 offen
  s_add_u32 m0, s33, 20480
  s_mov_b32 s32, 950272
  buffer_load_dwordx4 v8, s[12:15], s32 offen lds
  s_add_u32 m0, s33, 21504
  s_mov_b32 s32, 958464
  buffer_load_dwordx4 v8, s[12:15], s32 offen lds
  s_add_u32 m0, s33, 22528
  s_mov_b32 s32, 966656
  buffer_load_dwordx4 v8, s[12:15], s32 offen lds
  s_add_u32 m0, s33, 23552
  s_mov_b32 s32, 974848
  buffer_load_dwordx4 v8, s[12:15], s32 offen lds
  s_waitcnt vmcnt(48)
  s_waitcnt lgkmcnt(6)
  v_mfma_f32_32x32x16_bf16 a[0:15], v[176:179], v[144:147], a[0:15]
  ds_read_b64_tr_b16 v[192:193], v2 offset:4096
  s_waitcnt lgkmcnt(5)
  v_mfma_f32_32x32x16_bf16 a[16:31], v[180:183], v[144:147], a[16:31]
  ds_read_b64_tr_b16 v[194:195], v2 offset:4608
  v_mfma_f32_32x32x16_bf16 a[32:47], v[176:179], v[148:151], a[32:47]
  ds_read_b64_tr_b16 v[196:197], v3 offset:4096
  v_mfma_f32_32x32x16_bf16 a[48:63], v[180:183], v[148:151], a[48:63]
  ds_read_b64_tr_b16 v[198:199], v3 offset:4608
  v_mfma_f32_32x32x16_bf16 a[64:79], v[176:179], v[152:155], a[64:79]
  ds_read_b64_tr_b16 v[200:201], v2 offset:6144
  v_mfma_f32_32x32x16_bf16 a[80:95], v[180:183], v[152:155], a[80:95]
  ds_read_b64_tr_b16 v[202:203], v2 offset:6656
  v_mfma_f32_32x32x16_bf16 a[96:111], v[176:179], v[156:159], a[96:111]
  ds_read_b64_tr_b16 v[204:205], v3 offset:6144
  v_mfma_f32_32x32x16_bf16 a[112:127], v[180:183], v[156:159], a[112:127]
  ds_read_b64_tr_b16 v[206:207], v3 offset:6656
  s_mov_b32 s30, 59392
  buffer_load_dwordx4 v[144:147], v4, s[8:11], s30 offen
  buffer_load_dwordx4 v[148:151], v5, s[8:11], s30 offen
  buffer_load_dwordx4 v[152:155], v6, s[8:11], s30 offen
  buffer_load_dwordx4 v[156:159], v7, s[8:11], s30 offen
  s_waitcnt lgkmcnt(10)
  v_mfma_f32_32x32x16_bf16 a[0:15], v[184:187], v[160:163], a[0:15]
  s_waitcnt lgkmcnt(8)
  v_mfma_f32_32x32x16_bf16 a[16:31], v[188:191], v[160:163], a[16:31]
  v_mfma_f32_32x32x16_bf16 a[32:47], v[184:187], v[164:167], a[32:47]
  v_mfma_f32_32x32x16_bf16 a[48:63], v[188:191], v[164:167], a[48:63]
  v_mfma_f32_32x32x16_bf16 a[64:79], v[184:187], v[168:171], a[64:79]
  v_mfma_f32_32x32x16_bf16 a[80:95], v[188:191], v[168:171], a[80:95]
  v_mfma_f32_32x32x16_bf16 a[96:111], v[184:187], v[172:175], a[96:111]
  v_mfma_f32_32x32x16_bf16 a[112:127], v[188:191], v[172:175], a[112:127]
  s_mov_b32 s30, 60416
  buffer_load_dwordx4 v[160:163], v4, s[8:11], s30 offen
  buffer_load_dwordx4 v[164:167], v5, s[8:11], s30 offen
  buffer_load_dwordx4 v[168:171], v6, s[8:11], s30 offen
  buffer_load_dwordx4 v[172:175], v7, s[8:11], s30 offen
  s_add_u32 m0, s33, 0
  s_mov_b32 s32, 983040
  buffer_load_dwordx4 v8, s[12:15], s32 offen lds
  s_add_u32 m0, s33, 1024
  s_mov_b32 s32, 991232
  buffer_load_dwordx4 v8, s[12:15], s32 offen lds
  s_add_u32 m0, s33, 2048
  s_mov_b32 s32, 999424
  buffer_load_dwordx4 v8, s[12:15], s32 offen lds
  s_add_u32 m0, s33, 3072
  s_mov_b32 s32, 1007616
  buffer_load_dwordx4 v8, s[12:15], s32 offen lds
  s_waitcnt vmcnt(48)
  s_waitcnt lgkmcnt(6)
  v_mfma_f32_32x32x16_bf16 a[0:15], v[192:195], v[16:19], a[0:15]
  ds_read_b64_tr_b16 v[176:177], v2 offset:8192
  s_waitcnt lgkmcnt(5)
  v_mfma_f32_32x32x16_bf16 a[16:31], v[196:199], v[16:19], a[16:31]
  ds_read_b64_tr_b16 v[178:179], v2 offset:8704
  v_mfma_f32_32x32x16_bf16 a[32:47], v[192:195], v[20:23], a[32:47]
  ds_read_b64_tr_b16 v[180:181], v3 offset:8192
  v_mfma_f32_32x32x16_bf16 a[48:63], v[196:199], v[20:23], a[48:63]
  ds_read_b64_tr_b16 v[182:183], v3 offset:8704
  v_mfma_f32_32x32x16_bf16 a[64:79], v[192:195], v[24:27], a[64:79]
  ds_read_b64_tr_b16 v[184:185], v2 offset:10240
  v_mfma_f32_32x32x16_bf16 a[80:95], v[196:199], v[24:27], a[80:95]
  ds_read_b64_tr_b16 v[186:187], v2 offset:10752
  v_mfma_f32_32x32x16_bf16 a[96:111], v[192:195], v[28:31], a[96:111]
  ds_read_b64_tr_b16 v[188:189], v3 offset:10240
  v_mfma_f32_32x32x16_bf16 a[112:127], v[196:199], v[28:31], a[112:127]
  ds_read_b64_tr_b16 v[190:191], v3 offset:10752
  s_mov_b32 s30, 61440
  buffer_load_dwordx4 v[16:19], v4, s[8:11], s30 offen
  buffer_load_dwordx4 v[20:23], v5, s[8:11], s30 offen
  buffer_load_dwordx4 v[24:27], v6, s[8:11], s30 offen
  buffer_load_dwordx4 v[28:31], v7, s[8:11], s30 offen
  s_waitcnt lgkmcnt(10)
  v_mfma_f32_32x32x16_bf16 a[0:15], v[200:203], v[32:35], a[0:15]
  s_waitcnt lgkmcnt(8)
  v_mfma_f32_32x32x16_bf16 a[16:31], v[204:207], v[32:35], a[16:31]
  v_mfma_f32_32x32x16_bf16 a[32:47], v[200:203], v[36:39], a[32:47]
  v_mfma_f32_32x32x16_bf16 a[48:63], v[204:207], v[36:39], a[48:63]
  v_mfma_f32_32x32x16_bf16 a[64:79], v[200:203], v[40:43], a[64:79]
  v_mfma_f32_32x32x16_bf16 a[80:95], v[204:207], v[40:43], a[80:95]
  v_mfma_f32_32x32x16_bf16 a[96:111], v[200:203], v[44:47], a[96:111]
  v_mfma_f32_32x32x16_bf16 a[112:127], v[204:207], v[44:47], a[112:127]
  s_mov_b32 s30, 62464
  buffer_load_dwordx4 v[32:35], v4, s[8:11], s30 offen
  buffer_load_dwordx4 v[36:39], v5, s[8:11], s30 offen
  buffer_load_dwordx4 v[40:43], v6, s[8:11], s30 offen
  buffer_load_dwordx4 v[44:47], v7, s[8:11], s30 offen
  s_add_u32 m0, s33, 4096
  s_mov_b32 s32, 1015808
  buffer_load_dwordx4 v8, s[12:15], s32 offen lds
  s_add_u32 m0, s33, 5120
  s_mov_b32 s32, 1024000
  buffer_load_dwordx4 v8, s[12:15], s32 offen lds
  s_add_u32 m0, s33, 6144
  s_mov_b32 s32, 1032192
  buffer_load_dwordx4 v8, s[12:15], s32 offen lds
  s_add_u32 m0, s33, 7168
  s_mov_b32 s32, 1040384
  buffer_load_dwordx4 v8, s[12:15], s32 offen lds
  s_waitcnt vmcnt(48)
  s_waitcnt lgkmcnt(6)
  v_mfma_f32_32x32x16_bf16 a[0:15], v[176:179], v[48:51], a[0:15]
  ds_read_b64_tr_b16 v[192:193], v2 offset:12288
  s_waitcnt lgkmcnt(5)
  v_mfma_f32_32x32x16_bf16 a[16:31], v[180:183], v[48:51], a[16:31]
  ds_read_b64_tr_b16 v[194:195], v2 offset:12800
  v_mfma_f32_32x32x16_bf16 a[32:47], v[176:179], v[52:55], a[32:47]
  ds_read_b64_tr_b16 v[196:197], v3 offset:12288
  v_mfma_f32_32x32x16_bf16 a[48:63], v[180:183], v[52:55], a[48:63]
  ds_read_b64_tr_b16 v[198:199], v3 offset:12800
  v_mfma_f32_32x32x16_bf16 a[64:79], v[176:179], v[56:59], a[64:79]
  ds_read_b64_tr_b16 v[200:201], v2 offset:14336
  v_mfma_f32_32x32x16_bf16 a[80:95], v[180:183], v[56:59], a[80:95]
  ds_read_b64_tr_b16 v[202:203], v2 offset:14848
  v_mfma_f32_32x32x16_bf16 a[96:111], v[176:179], v[60:63], a[96:111]
  ds_read_b64_tr_b16 v[204:205], v3 offset:14336
  v_mfma_f32_32x32x16_bf16 a[112:127], v[180:183], v[60:63], a[112:127]
  ds_read_b64_tr_b16 v[206:207], v3 offset:14848
  s_mov_b32 s30, 63488
  buffer_load_dwordx4 v[48:51], v4, s[8:11], s30 offen
  buffer_load_dwordx4 v[52:55], v5, s[8:11], s30 offen
  buffer_load_dwordx4 v[56:59], v6, s[8:11], s30 offen
  buffer_load_dwordx4 v[60:63], v7, s[8:11], s30 offen
  s_waitcnt lgkmcnt(10)
  v_mfma_f32_32x32x16_bf16 a[0:15], v[184:187], v[64:67], a[0:15]
  s_waitcnt lgkmcnt(8)
  v_mfma_f32_32x32x16_bf16 a[16:31], v[188:191], v[64:67], a[16:31]
  v_mfma_f32_32x32x16_bf16 a[32:47], v[184:187], v[68:71], a[32:47]
  v_mfma_f32_32x32x16_bf16 a[48:63], v[188:191], v[68:71], a[48:63]
  v_mfma_f32_32x32x16_bf16 a[64:79], v[184:187], v[72:75], a[64:79]
  v_mfma_f32_32x32x16_bf16 a[80:95], v[188:191], v[72:75], a[80:95]
  v_mfma_f32_32x32x16_bf16 a[96:111], v[184:187], v[76:79], a[96:111]
  v_mfma_f32_32x32x16_bf16 a[112:127], v[188:191], v[76:79], a[112:127]
  s_mov_b32 s30, 64512
  buffer_load_dwordx4 v[64:67], v4, s[8:11], s30 offen
  buffer_load_dwordx4 v[68:71], v5, s[8:11], s30 offen
  buffer_load_dwordx4 v[72:75], v6, s[8:11], s30 offen
  buffer_load_dwordx4 v[76:79], v7, s[8:11], s30 offen
  s_waitcnt vmcnt(44)
  s_waitcnt lgkmcnt(6)
  v_mfma_f32_32x32x16_bf16 a[0:15], v[192:195], v[80:83], a[0:15]
  ds_read_b64_tr_b16 v[176:177], v2 offset:16384
  s_waitcnt lgkmcnt(5)
  v_mfma_f32_32x32x16_bf16 a[16:31], v[196:199], v[80:83], a[16:31]
  ds_read_b64_tr_b16 v[178:179], v2 offset:16896
  v_mfma_f32_32x32x16_bf16 a[32:47], v[192:195], v[84:87], a[32:47]
  ds_read_b64_tr_b16 v[180:181], v3 offset:16384
  v_mfma_f32_32x32x16_bf16 a[48:63], v[196:199], v[84:87], a[48:63]
  ds_read_b64_tr_b16 v[182:183], v3 offset:16896
  v_mfma_f32_32x32x16_bf16 a[64:79], v[192:195], v[88:91], a[64:79]
  ds_read_b64_tr_b16 v[184:185], v2 offset:18432
  v_mfma_f32_32x32x16_bf16 a[80:95], v[196:199], v[88:91], a[80:95]
  ds_read_b64_tr_b16 v[186:187], v2 offset:18944
  v_mfma_f32_32x32x16_bf16 a[96:111], v[192:195], v[92:95], a[96:111]
  ds_read_b64_tr_b16 v[188:189], v3 offset:18432
  v_mfma_f32_32x32x16_bf16 a[112:127], v[196:199], v[92:95], a[112:127]
  ds_read_b64_tr_b16 v[190:191], v3 offset:18944
  s_waitcnt lgkmcnt(10)
  v_mfma_f32_32x32x16_bf16 a[0:15], v[200:203], v[96:99], a[0:15]
  s_waitcnt lgkmcnt(8)
  v_mfma_f32_32x32x16_bf16 a[16:31], v[204:207], v[96:99], a[16:31]
  v_mfma_f32_32x32x16_bf16 a[32:47], v[200:203], v[100:103], a[32:47]
  v_mfma_f32_32x32x16_bf16 a[48:63], v[204:207], v[100:103], a[48:63]
  v_mfma_f32_32x32x16_bf16 a[64:79], v[200:203], v[104:107], a[64:79]
  v_mfma_f32_32x32x16_bf16 a[80:95], v[204:207], v[104:107], a[80:95]
  v_mfma_f32_32x32x16_bf16 a[96:111], v[200:203], v[108:111], a[96:111]
  v_mfma_f32_32x32x16_bf16 a[112:127], v[204:207], v[108:111], a[112:127]
  s_waitcnt vmcnt(32)
  s_waitcnt lgkmcnt(6)
  v_mfma_f32_32x32x16_bf16 a[0:15], v[176:179], v[112:115], a[0:15]
  ds_read_b64_tr_b16 v[192:193], v2 offset:20480
  s_waitcnt lgkmcnt(5)
  v_mfma_f32_32x32x16_bf16 a[16:31], v[180:183], v[112:115], a[16:31]
  ds_read_b64_tr_b16 v[194:195], v2 offset:20992
  v_mfma_f32_32x32x16_bf16 a[32:47], v[176:179], v[116:119], a[32:47]
  ds_read_b64_tr_b16 v[196:197], v3 offset:20480
  v_mfma_f32_32x32x16_bf16 a[48:63], v[180:183], v[116:119], a[48:63]
  ds_read_b64_tr_b16 v[198:199], v3 offset:20992
  v_mfma_f32_32x32x16_bf16 a[64:79], v[176:179], v[120:123], a[64:79]
  ds_read_b64_tr_b16 v[200:201], v2 offset:22528
  v_mfma_f32_32x32x16_bf16 a[80:95], v[180:183], v[120:123], a[80:95]
  ds_read_b64_tr_b16 v[202:203], v2 offset:23040
  v_mfma_f32_32x32x16_bf16 a[96:111], v[176:179], v[124:127], a[96:111]
  ds_read_b64_tr_b16 v[204:205], v3 offset:22528
  v_mfma_f32_32x32x16_bf16 a[112:127], v[180:183], v[124:127], a[112:127]
  ds_read_b64_tr_b16 v[206:207], v3 offset:23040
  s_waitcnt lgkmcnt(10)
  v_mfma_f32_32x32x16_bf16 a[0:15], v[184:187], v[128:131], a[0:15]
  s_waitcnt lgkmcnt(8)
  v_mfma_f32_32x32x16_bf16 a[16:31], v[188:191], v[128:131], a[16:31]
  v_mfma_f32_32x32x16_bf16 a[32:47], v[184:187], v[132:135], a[32:47]
  v_mfma_f32_32x32x16_bf16 a[48:63], v[188:191], v[132:135], a[48:63]
  v_mfma_f32_32x32x16_bf16 a[64:79], v[184:187], v[136:139], a[64:79]
  v_mfma_f32_32x32x16_bf16 a[80:95], v[188:191], v[136:139], a[80:95]
  v_mfma_f32_32x32x16_bf16 a[96:111], v[184:187], v[140:143], a[96:111]
  v_mfma_f32_32x32x16_bf16 a[112:127], v[188:191], v[140:143], a[112:127]
  s_waitcnt vmcnt(20)
  s_waitcnt lgkmcnt(6)
  v_mfma_f32_32x32x16_bf16 a[0:15], v[192:195], v[144:147], a[0:15]
  ds_read_b64_tr_b16 v[176:177], v2 offset:0
  s_waitcnt lgkmcnt(5)
  v_mfma_f32_32x32x16_bf16 a[16:31], v[196:199], v[144:147], a[16:31]
  ds_read_b64_tr_b16 v[178:179], v2 offset:512
  v_mfma_f32_32x32x16_bf16 a[32:47], v[192:195], v[148:151], a[32:47]
  ds_read_b64_tr_b16 v[180:181], v3 offset:0
  v_mfma_f32_32x32x16_bf16 a[48:63], v[196:199], v[148:151], a[48:63]
  ds_read_b64_tr_b16 v[182:183], v3 offset:512
  v_mfma_f32_32x32x16_bf16 a[64:79], v[192:195], v[152:155], a[64:79]
  ds_read_b64_tr_b16 v[184:185], v2 offset:2048
  v_mfma_f32_32x32x16_bf16 a[80:95], v[196:199], v[152:155], a[80:95]
  ds_read_b64_tr_b16 v[186:187], v2 offset:2560
  v_mfma_f32_32x32x16_bf16 a[96:111], v[192:195], v[156:159], a[96:111]
  ds_read_b64_tr_b16 v[188:189], v3 offset:2048
  v_mfma_f32_32x32x16_bf16 a[112:127], v[196:199], v[156:159], a[112:127]
  ds_read_b64_tr_b16 v[190:191], v3 offset:2560
  s_waitcnt lgkmcnt(10)
  v_mfma_f32_32x32x16_bf16 a[0:15], v[200:203], v[160:163], a[0:15]
  s_waitcnt lgkmcnt(8)
  v_mfma_f32_32x32x16_bf16 a[16:31], v[204:207], v[160:163], a[16:31]
  v_mfma_f32_32x32x16_bf16 a[32:47], v[200:203], v[164:167], a[32:47]
  v_mfma_f32_32x32x16_bf16 a[48:63], v[204:207], v[164:167], a[48:63]
  v_mfma_f32_32x32x16_bf16 a[64:79], v[200:203], v[168:171], a[64:79]
  v_mfma_f32_32x32x16_bf16 a[80:95], v[204:207], v[168:171], a[80:95]
  v_mfma_f32_32x32x16_bf16 a[96:111], v[200:203], v[172:175], a[96:111]
  v_mfma_f32_32x32x16_bf16 a[112:127], v[204:207], v[172:175], a[112:127]
  s_waitcnt vmcnt(8)
  s_waitcnt lgkmcnt(6)
  v_mfma_f32_32x32x16_bf16 a[0:15], v[176:179], v[16:19], a[0:15]
  ds_read_b64_tr_b16 v[192:193], v2 offset:4096
  s_waitcnt lgkmcnt(5)
  v_mfma_f32_32x32x16_bf16 a[16:31], v[180:183], v[16:19], a[16:31]
  ds_read_b64_tr_b16 v[194:195], v2 offset:4608
  v_mfma_f32_32x32x16_bf16 a[32:47], v[176:179], v[20:23], a[32:47]
  ds_read_b64_tr_b16 v[196:197], v3 offset:4096
  v_mfma_f32_32x32x16_bf16 a[48:63], v[180:183], v[20:23], a[48:63]
  ds_read_b64_tr_b16 v[198:199], v3 offset:4608
  v_mfma_f32_32x32x16_bf16 a[64:79], v[176:179], v[24:27], a[64:79]
  ds_read_b64_tr_b16 v[200:201], v2 offset:6144
  v_mfma_f32_32x32x16_bf16 a[80:95], v[180:183], v[24:27], a[80:95]
  ds_read_b64_tr_b16 v[202:203], v2 offset:6656
  v_mfma_f32_32x32x16_bf16 a[96:111], v[176:179], v[28:31], a[96:111]
  ds_read_b64_tr_b16 v[204:205], v3 offset:6144
  v_mfma_f32_32x32x16_bf16 a[112:127], v[180:183], v[28:31], a[112:127]
  ds_read_b64_tr_b16 v[206:207], v3 offset:6656
  s_waitcnt lgkmcnt(10)
  v_mfma_f32_32x32x16_bf16 a[0:15], v[184:187], v[32:35], a[0:15]
  s_waitcnt lgkmcnt(8)
  v_mfma_f32_32x32x16_bf16 a[16:31], v[188:191], v[32:35], a[16:31]
  v_mfma_f32_32x32x16_bf16 a[32:47], v[184:187], v[36:39], a[32:47]
  v_mfma_f32_32x32x16_bf16 a[48:63], v[188:191], v[36:39], a[48:63]
  v_mfma_f32_32x32x16_bf16 a[64:79], v[184:187], v[40:43], a[64:79]
  v_mfma_f32_32x32x16_bf16 a[80:95], v[188:191], v[40:43], a[80:95]
  v_mfma_f32_32x32x16_bf16 a[96:111], v[184:187], v[44:47], a[96:111]
  v_mfma_f32_32x32x16_bf16 a[112:127], v[188:191], v[44:47], a[112:127]
  s_waitcnt vmcnt(0)
  s_waitcnt lgkmcnt(6)
  v_mfma_f32_32x32x16_bf16 a[0:15], v[192:195], v[48:51], a[0:15]
  s_waitcnt lgkmcnt(4)
  v_mfma_f32_32x32x16_bf16 a[16:31], v[196:199], v[48:51], a[16:31]
  v_mfma_f32_32x32x16_bf16 a[32:47], v[192:195], v[52:55], a[32:47]
  v_mfma_f32_32x32x16_bf16 a[48:63], v[196:199], v[52:55], a[48:63]
  v_mfma_f32_32x32x16_bf16 a[64:79], v[192:195], v[56:59], a[64:79]
  v_mfma_f32_32x32x16_bf16 a[80:95], v[196:199], v[56:59], a[80:95]
  v_mfma_f32_32x32x16_bf16 a[96:111], v[192:195], v[60:63], a[96:111]
  v_mfma_f32_32x32x16_bf16 a[112:127], v[196:199], v[60:63], a[112:127]
  s_waitcnt lgkmcnt(2)
  v_mfma_f32_32x32x16_bf16 a[0:15], v[200:203], v[64:67], a[0:15]
  s_waitcnt lgkmcnt(0)
  v_mfma_f32_32x32x16_bf16 a[16:31], v[204:207], v[64:67], a[16:31]
  v_mfma_f32_32x32x16_bf16 a[32:47], v[200:203], v[68:71], a[32:47]
  v_mfma_f32_32x32x16_bf16 a[48:63], v[204:207], v[68:71], a[48:63]
  v_mfma_f32_32x32x16_bf16 a[64:79], v[200:203], v[72:75], a[64:79]
  v_mfma_f32_32x32x16_bf16 a[80:95], v[204:207], v[72:75], a[80:95]
  v_mfma_f32_32x32x16_bf16 a[96:111], v[200:203], v[76:79], a[96:111]
  v_mfma_f32_32x32x16_bf16 a[112:127], v[204:207], v[76:79], a[112:127]
  s_waitcnt lgkmcnt(0)
  s_nop 13
  s_barrier
  v_lshlrev_b32 v10, 4, v0
  s_lshl_b32 s28, s3, 15
  v_add_u32 v11, s28, v10
  ds_write_b128 v11, a[0:3] offset:0
  ds_write_b128 v11, a[4:7] offset:1024
  ds_write_b128 v11, a[8:11] offset:2048
  ds_write_b128 v11, a[12:15] offset:3072
  ds_write_b128 v11, a[16:19] offset:4096
  ds_write_b128 v11, a[20:23] offset:5120
  ds_write_b128 v11, a[24:27] offset:6144
  ds_write_b128 v11, a[28:31] offset:7168
  ds_write_b128 v11, a[32:35] offset:8192
  ds_write_b128 v11, a[36:39] offset:9216
  ds_write_b128 v11, a[40:43] offset:10240
  ds_write_b128 v11, a[44:47] offset:11264
  ds_write_b128 v11, a[48:51] offset:12288
  ds_write_b128 v11, a[52:55] offset:13312
  ds_write_b128 v11, a[56:59] offset:14336
  ds_write_b128 v11, a[60:63] offset:15360
  ds_write_b128 v11, a[64:67] offset:16384
  ds_write_b128 v11, a[68:71] offset:17408
  ds_write_b128 v11, a[72:75] offset:18432
  ds_write_b128 v11, a[76:79] offset:19456
  ds_write_b128 v11, a[80:83] offset:20480
  ds_write_b128 v11, a[84:87] offset:21504
  ds_write_b128 v11, a[88:91] offset:22528
  ds_write_b128 v11, a[92:95] offset:23552
  ds_write_b128 v11, a[96:99] offset:24576
  ds_write_b128 v11, a[100:103] offset:25600
  ds_write_b128 v11, a[104:107] offset:26624
  ds_write_b128 v11, a[108:111] offset:27648
  ds_write_b128 v11, a[112:115] offset:28672
  ds_write_b128 v11, a[116:119] offset:29696
  ds_write_b128 v11, a[120:123] offset:30720
  ds_write_b128 v11, a[124:127] offset:31744
  s_waitcnt lgkmcnt(0)
  s_barrier
  s_lshl_b32 s28, s3, 13
  v_add_u32 v11, s28, v10
  v_add_u32 v12, 0x10000, v11
  ds_read_b128 v[16:19], v11 offset:0
  ds_read_b128 v[20:23], v11 offset:1024
  ds_read_b128 v[24:27], v11 offset:2048
  ds_read_b128 v[28:31], v11 offset:3072
  ds_read_b128 v[32:35], v11 offset:4096
  ds_read_b128 v[36:39], v11 offset:5120
  ds_read_b128 v[40:43], v11 offset:6144
  ds_read_b128 v[44:47], v11 offset:7168
  ds_read_b128 v[48:51], v11 offset:32768
  ds_read_b128 v[52:55], v11 offset:33792
  ds_read_b128 v[56:59], v11 offset:34816
  ds_read_b128 v[60:63], v11 offset:35840
  ds_read_b128 v[64:67], v11 offset:36864
  ds_read_b128 v[68:71], v11 offset:37888
  ds_read_b128 v[72:75], v11 offset:38912
  ds_read_b128 v[76:79], v11 offset:39936
  ds_read_b128 v[80:83], v12 offset:0
  ds_read_b128 v[84:87], v12 offset:1024
  ds_read_b128 v[88:91], v12 offset:2048
  ds_read_b128 v[92:95], v12 offset:3072
  ds_read_b128 v[96:99], v12 offset:4096
  ds_read_b128 v[100:103], v12 offset:5120
  ds_read_b128 v[104:107], v12 offset:6144
  ds_read_b128 v[108:111], v12 offset:7168
  ds_read_b128 v[112:115], v12 offset:32768
  ds_read_b128 v[116:119], v12 offset:33792
  ds_read_b128 v[120:123], v12 offset:34816
  ds_read_b128 v[124:127], v12 offset:35840
  ds_read_b128 v[128:131], v12 offset:36864
  ds_read_b128 v[132:135], v12 offset:37888
  ds_read_b128 v[136:139], v12 offset:38912
  ds_read_b128 v[140:143], v12 offset:39936
  s_waitcnt lgkmcnt(15)
  v_add_f32 v16, v16, v48
  s_waitcnt lgkmcnt(7)
  v_add_f32 v80, v80, v112
  v_add_f32 v16, v16, v80
  v_add_f32 v17, v17, v49
  v_add_f32 v81, v81, v113
  v_add_f32 v17, v17, v81
  v_add_f32 v18, v18, v50
  v_add_f32 v82, v82, v114
  v_add_f32 v18, v18, v82
  v_add_f32 v19, v19, v51
  v_add_f32 v83, v83, v115
  v_add_f32 v19, v19, v83
  v_add_f32 v20, v20, v52
  s_waitcnt lgkmcnt(6)
  v_add_f32 v84, v84, v116
  v_add_f32 v20, v20, v84
  v_add_f32 v21, v21, v53
  v_add_f32 v85, v85, v117
  v_add_f32 v21, v21, v85
  v_add_f32 v22, v22, v54
  v_add_f32 v86, v86, v118
  v_add_f32 v22, v22, v86
  v_add_f32 v23, v23, v55
  v_add_f32 v87, v87, v119
  v_add_f32 v23, v23, v87
  v_add_f32 v24, v24, v56
  s_waitcnt lgkmcnt(5)
  v_add_f32 v88, v88, v120
  v_add_f32 v24, v24, v88
  v_add_f32 v25, v25, v57
  v_add_f32 v89, v89, v121
  v_add_f32 v25, v25, v89
  v_add_f32 v26, v26, v58
  v_add_f32 v90, v90, v122
  v_add_f32 v26, v26, v90
  v_add_f32 v27, v27, v59
  v_add_f32 v91, v91, v123
  v_add_f32 v27, v27, v91
  v_add_f32 v28, v28, v60
  s_waitcnt lgkmcnt(4)
  v_add_f32 v92, v92, v124
  v_add_f32 v28, v28, v92
  v_add_f32 v29, v29, v61
  v_add_f32 v93, v93, v125
  v_add_f32 v29, v29, v93
  v_add_f32 v30, v30, v62
  v_add_f32 v94, v94, v126
  v_add_f32 v30, v30, v94
  v_add_f32 v31, v31, v63
  v_add_f32 v95, v95, v127
  v_add_f32 v31, v31, v95
  v_add_f32 v32, v32, v64
  s_waitcnt lgkmcnt(3)
  v_add_f32 v96, v96, v128
  v_add_f32 v32, v32, v96
  v_add_f32 v33, v33, v65
  v_add_f32 v97, v97, v129
  v_add_f32 v33, v33, v97
  v_add_f32 v34, v34, v66
  v_add_f32 v98, v98, v130
  v_add_f32 v34, v34, v98
  v_add_f32 v35, v35, v67
  v_add_f32 v99, v99, v131
  v_add_f32 v35, v35, v99
  v_add_f32 v36, v36, v68
  s_waitcnt lgkmcnt(2)
  v_add_f32 v100, v100, v132
  v_add_f32 v36, v36, v100
  v_add_f32 v37, v37, v69
  v_add_f32 v101, v101, v133
  v_add_f32 v37, v37, v101
  v_add_f32 v38, v38, v70
  v_add_f32 v102, v102, v134
  v_add_f32 v38, v38, v102
  v_add_f32 v39, v39, v71
  v_add_f32 v103, v103, v135
  v_add_f32 v39, v39, v103
  v_add_f32 v40, v40, v72
  s_waitcnt lgkmcnt(1)
  v_add_f32 v104, v104, v136
  v_add_f32 v40, v40, v104
  v_add_f32 v41, v41, v73
  v_add_f32 v105, v105, v137
  v_add_f32 v41, v41, v105
  v_add_f32 v42, v42, v74
  v_add_f32 v106, v106, v138
  v_add_f32 v42, v42, v106
  v_add_f32 v43, v43, v75
  v_add_f32 v107, v107, v139
  v_add_f32 v43, v43, v107
  v_add_f32 v44, v44, v76
  s_waitcnt lgkmcnt(0)
  v_add_f32 v108, v108, v140
  v_add_f32 v44, v44, v108
  v_add_f32 v45, v45, v77
  v_add_f32 v109, v109, v141
  v_add_f32 v45, v45, v109
  v_add_f32 v46, v46, v78
  v_add_f32 v110, v110, v142
  v_add_f32 v46, v46, v110
  v_add_f32 v47, v47, v79
  v_add_f32 v111, v111, v143
  v_add_f32 v47, v47, v111
  v_cvt_pk_bf16_f32 v144, v16, v17
  v_cvt_pk_bf16_f32 v145, v18, v19
  v_cvt_pk_bf16_f32 v146, v20, v21
  v_cvt_pk_bf16_f32 v147, v22, v23
  buffer_store_dwordx4 v[144:147], v9, s[16:19], 0 offen offset:0
  v_cvt_pk_bf16_f32 v148, v24, v25
  v_cvt_pk_bf16_f32 v149, v26, v27
  v_cvt_pk_bf16_f32 v150, v28, v29
  v_cvt_pk_bf16_f32 v151, v30, v31
  buffer_store_dwordx4 v[148:151], v9, s[16:19], 0 offen offset:32
  v_cvt_pk_bf16_f32 v152, v32, v33
  v_cvt_pk_bf16_f32 v153, v34, v35
  v_cvt_pk_bf16_f32 v154, v36, v37
  v_cvt_pk_bf16_f32 v155, v38, v39
  buffer_store_dwordx4 v[152:155], v9, s[16:19], 0 offen offset:64
  v_cvt_pk_bf16_f32 v156, v40, v41
  v_cvt_pk_bf16_f32 v157, v42, v43
  v_cvt_pk_bf16_f32 v158, v44, v45
  v_cvt_pk_bf16_f32 v159, v46, v47
  buffer_store_dwordx4 v[156:159], v9, s[16:19], 0 offen offset:96
  s_waitcnt vmcnt(0)
K2_EXIT:
  s_endpgm
.section .rodata,"a"
.p2align 6
.amdhsa_kernel attn_kernel
  .amdhsa_next_free_vgpr 256
  .amdhsa_next_free_sgpr 102
  .amdhsa_accum_offset 256
  .amdhsa_group_segment_fixed_size 0
  .amdhsa_kernarg_size 104
  .amdhsa_user_sgpr_count 2
  .amdhsa_user_sgpr_kernarg_segment_ptr 1
  .amdhsa_system_sgpr_workgroup_id_x 1
.end_amdhsa_kernel
.p2align 6
.amdhsa_kernel oproj_kernel
  .amdhsa_next_free_vgpr 384
  .amdhsa_next_free_sgpr 102
  .amdhsa_accum_offset 256
  .amdhsa_group_segment_fixed_size 0
  .amdhsa_kernarg_size 104
  .amdhsa_user_sgpr_count 2
  .amdhsa_user_sgpr_kernarg_segment_ptr 1
  .amdhsa_system_sgpr_workgroup_id_x 1
.end_amdhsa_kernel
```
